```python
import torch

def _softmax(x, axis=-1):
    return torch.softmax(x, dim=axis)
def _gelu(x):
    return torch.nn.functional.gelu(x, approximate="tanh")
def _silu(x):
    return torch.nn.functional.silu(x)
def _sigmoid(x):
    return torch.sigmoid(x)
def _layernorm(x, axis=-1, eps=1e-5):
    m = x.mean(dim=axis, keepdim=True)
    v = x.var(dim=axis, keepdim=True, unbiased=False)
    return (x - m) / torch.sqrt(v + eps)
def _scatter_add(tgt, idx, src, axis=0):
    return tgt.clone().index_add_(axis, idx, src)
def _segment_sum(src, seg, n):
    out = torch.zeros((n,) + src.shape[1:], dtype=src.dtype)
    return out.index_add_(0, seg, src)
def _pad(x, pw):
    flat = tuple(v for pair in reversed(pw) for v in pair)
    return torch.nn.functional.pad(x, flat)

kernel_name = 'parallel_sum__gqa_block_cached__glu_gated_reglu__decode'

def setup_inputs():

    _w = (lambda a: (lambda t: t.to(torch.bfloat16) if t.is_floating_point() else t)(torch.as_tensor(a)))
    def _A_setup():
        B, Sq, D = 4, 1, 640
        Hq, Hkv, Sk, Dh = 32, 32, 8192, 128
        assert Hq % Hkv == 0, (Hq, Hkv)
        return {
            "x": _w((lambda *s: torch.randn(*s, dtype=torch.bfloat16) * 0.05)(B, Sq, D)),
            "k_cache": _w((lambda *s: torch.randn(*s, dtype=torch.bfloat16) * 1.6)(B, Hkv, Sk, Dh)),
            "v_cache": _w((lambda *s: torch.randn(*s, dtype=torch.bfloat16) * 0.8)(B, Hkv, Sk, Dh)),
            "wq": _w((lambda *s: torch.randn(*s, dtype=torch.bfloat16) * 1.6)(D, Hq * Dh) * (D ** -0.5)),
            "wo": _w((lambda *s: torch.randn(*s, dtype=torch.bfloat16) * 0.8)(Hq * Dh, D) * ((Hq * Dh) ** -0.5)),
        }
    _A_in = _A_setup()

    def _B_setup():
        B, S, D, F = 4, 1, 640, 1728
        return {
            "x": _w((lambda *s: torch.randn(*s, dtype=torch.bfloat16) * 0.05)(B, S, D)),
            "W_gate": _w((lambda *s: torch.randn(*s, dtype=torch.bfloat16) * 0.4)(D, F) * (2.0 / D) ** 0.5),
            "W_up": _w((lambda *s: torch.randn(*s, dtype=torch.bfloat16) * 0.4)(D, F) * (2.0 / D) ** 0.5),
            "W_down": _w((lambda *s: torch.randn(*s, dtype=torch.bfloat16) * 0.4)(F, D) * (1.0 / F) ** 0.5),
        }
    _B_in = _B_setup()

    return {
        "A_x": _A_in["x"],
        "A_k_cache": _A_in["k_cache"],
        "A_v_cache": _A_in["v_cache"],
        "A_wq": _A_in["wq"],
        "A_wo": _A_in["wo"],
        "B_x": _B_in["x"],
        "B_W_gate": _B_in["W_gate"],
        "B_W_up": _B_in["W_up"],
        "B_W_down": _B_in["W_down"],
    }

def reference(A_x, A_k_cache, A_v_cache, A_wq, A_wo, B_x, B_W_gate, B_W_up, B_W_down):
    def _A_ref(x, k_cache, v_cache, wq, wo):
        B, Sq, D = x.shape
        Hq, Dh = 32, 128
        Hkv = k_cache.shape[1]
        rep = Hq // Hkv
        q = (lambda x, *d: x.permute(*d))((x @ wq).reshape(B, Sq, Hq, Dh), 0, 2, 1, 3)
        k = (lambda x, n, axis: torch.repeat_interleave(x, n, dim=axis))(k_cache, rep, axis=1)
        v = (lambda x, n, axis: torch.repeat_interleave(x, n, dim=axis))(v_cache, rep, axis=1)
        scores = torch.einsum("bhqd,bhkd->bhqk", q, k) * (Dh ** -0.5)
        p = _softmax(scores, axis=-1)
        o = torch.einsum("bhqk,bhkd->bhqd", p, v)
        return (lambda x, *d: x.permute(*d))(o, 0, 2, 1, 3).reshape(B, Sq, Hq * Dh) @ wo

    def _B_ref(x, W_gate, W_up, W_down):
        gate = torch.einsum("bsd,df->bsf", x, W_gate)
        up = torch.einsum("bsd,df->bsf", x, W_up)
        gate = gate * (lambda x, dt: x.to(dt))(gate > 0, gate.dtype)
        h = gate * up
        return torch.einsum("bsf,fd->bsd", h, W_down)

    x = A_x
    xn = _layernorm(x, axis=-1)
    return x + _A_ref(xn, A_k_cache, A_v_cache, A_wq, A_wo) + _B_ref(xn, B_W_gate, B_W_up, B_W_down)
```

```asm
; @launch grid=(256,1,1) block=(512,1,1) lds=14848
.amdgcn_target "amdgcn-amd-amdhsa--gfx950"
.text
.globl parallel_sum__gqa_block_cached__glu_gated_reglu__decode_kernel
.p2align 8
.type parallel_sum__gqa_block_cached__glu_gated_reglu__decode_kernel,@function
parallel_sum__gqa_block_cached__glu_gated_reglu__decode_kernel:
    s_cmp_ge_u32 s2, 256
    s_cbranch_scc1 L_end
    s_load_dwordx16 s[4:19], s[0:1], 0
    s_load_dwordx8 s[20:27], s[0:1], 64
    v_lshrrev_b32 v1, 6, v0
    v_and_b32 v0, 63, v0
    v_readfirstlane_b32 s3, v1
    s_and_b32 s32, s2, 7
    s_lshr_b32 s35, s2, 3
    s_lshr_b32 s36, s35, 3
    s_and_b32 s37, s35, 7
    s_lshr_b32 s28, s37, 1
    s_and_b32 s38, s37, 1
    s_lshl_b32 s39, s36, 3
    s_add_u32 s29, s32, s39
    s_lshl_b32 s39, s28, 5
    s_add_u32 s39, s39, s29
    s_lshl_b32 s39, s39, 1
    s_add_u32 s30, s39, s38
    s_lshl_b32 s33, s36, 1
    s_add_u32 s33, s33, s38
    s_lshl_b32 s31, s33, 3
    s_add_u32 s31, s31, s32
    v_and_b32 v2, 15, v0
    v_lshrrev_b32 v3, 4, v0
    v_and_b32 v8, 1, v2
    v_lshlrev_b32 v8, 4, v8
    v_mov_b32 v9, 0xffff
    v_lshlrev_b32 v9, v8, v9
    v_lshrrev_b32 v10, 1, v2
    v_cmp_eq_u32 vcc, 0, v10
    s_nop 1
    v_cndmask_b32 v4, 0, v9, vcc
    v_cmp_eq_u32 vcc, 1, v10
    s_nop 1
    v_cndmask_b32 v5, 0, v9, vcc
    v_cmp_eq_u32 vcc, 2, v10
    s_nop 1
    v_cndmask_b32 v6, 0, v9, vcc
    v_cmp_eq_u32 vcc, 3, v10
    s_nop 1
    v_cndmask_b32 v7, 0, v9, vcc
    s_waitcnt lgkmcnt(0)
    s_cmp_ge_u32 s3, 4
    s_cbranch_scc1 L_service
    s_lshl_b32 s35, s30, 20
    s_lshr_b32 s36, s30, 12
    s_add_u32 s40, s6, s35
    s_addc_u32 s41, s7, s36
    s_and_b32 s41, s41, 0xffff
    s_mov_b32 s42, 0x100000
    s_mov_b32 s43, 0x20000
    s_add_u32 s44, s8, s35
    s_addc_u32 s45, s9, s36
    s_and_b32 s45, s45, 0xffff
    s_mul_i32 s35, s3, 4096
    v_lshlrev_b32 v11, 4, v0
    v_add_u32 v11, s35, v11
    s_mov_b32 s46, 0
    s_barrier
    buffer_load_dwordx4 v[128:131], v11, s[40:43], s46 offen offset:0 nt
    buffer_load_dwordx4 v[132:135], v11, s[40:43], s46 offen offset:1024 nt
    buffer_load_dwordx4 v[136:139], v11, s[40:43], s46 offen offset:2048 nt
    buffer_load_dwordx4 v[140:143], v11, s[40:43], s46 offen offset:3072 nt
    s_add_u32 s46, s46, 16384
    buffer_load_dwordx4 v[144:147], v11, s[40:43], s46 offen offset:0 nt
    buffer_load_dwordx4 v[148:151], v11, s[40:43], s46 offen offset:1024 nt
    s_waitcnt vmcnt(4)
    buffer_load_dwordx4 v[152:155], v11, s[40:43], s46 offen offset:2048 nt
    buffer_load_dwordx4 v[156:159], v11, s[40:43], s46 offen offset:3072 nt
    s_add_u32 s46, s46, 16384
    s_waitcnt vmcnt(4)
    buffer_load_dwordx4 v[160:163], v11, s[40:43], s46 offen offset:0 nt
    buffer_load_dwordx4 v[164:167], v11, s[40:43], s46 offen offset:1024 nt
    s_waitcnt vmcnt(4)
    buffer_load_dwordx4 v[168:171], v11, s[40:43], s46 offen offset:2048 nt
    buffer_load_dwordx4 v[172:175], v11, s[40:43], s46 offen offset:3072 nt
    s_add_u32 s46, s46, 16384
    s_waitcnt vmcnt(4)
    buffer_load_dwordx4 v[176:179], v11, s[40:43], s46 offen offset:0 nt
    buffer_load_dwordx4 v[180:183], v11, s[40:43], s46 offen offset:1024 nt
    s_waitcnt vmcnt(4)
    buffer_load_dwordx4 v[184:187], v11, s[40:43], s46 offen offset:2048 nt
    buffer_load_dwordx4 v[188:191], v11, s[40:43], s46 offen offset:3072 nt
    s_add_u32 s46, s46, 16384
    s_waitcnt vmcnt(4)
    buffer_load_dwordx4 v[192:195], v11, s[40:43], s46 offen offset:0 nt
    buffer_load_dwordx4 v[196:199], v11, s[40:43], s46 offen offset:1024 nt
    s_waitcnt vmcnt(4)
    buffer_load_dwordx4 v[200:203], v11, s[40:43], s46 offen offset:2048 nt
    buffer_load_dwordx4 v[204:207], v11, s[40:43], s46 offen offset:3072 nt
    s_add_u32 s46, s46, 16384
    s_waitcnt vmcnt(4)
    buffer_load_dwordx4 v[208:211], v11, s[40:43], s46 offen offset:0 nt
    buffer_load_dwordx4 v[212:215], v11, s[40:43], s46 offen offset:1024 nt
    s_waitcnt vmcnt(4)
    buffer_load_dwordx4 v[216:219], v11, s[40:43], s46 offen offset:2048 nt
    buffer_load_dwordx4 v[220:223], v11, s[40:43], s46 offen offset:3072 nt
    s_add_u32 s46, s46, 16384
    s_waitcnt vmcnt(4)
    buffer_load_dwordx4 v[224:227], v11, s[40:43], s46 offen offset:0 nt
    buffer_load_dwordx4 v[228:231], v11, s[40:43], s46 offen offset:1024 nt
    s_waitcnt vmcnt(4)
    buffer_load_dwordx4 v[232:235], v11, s[40:43], s46 offen offset:2048 nt
    buffer_load_dwordx4 v[236:239], v11, s[40:43], s46 offen offset:3072 nt
    s_add_u32 s46, s46, 16384
    s_waitcnt vmcnt(4)
    buffer_load_dwordx4 v[240:243], v11, s[40:43], s46 offen offset:0 nt
    buffer_load_dwordx4 v[244:247], v11, s[40:43], s46 offen offset:1024 nt
    s_waitcnt vmcnt(4)
    buffer_load_dwordx4 v[248:251], v11, s[40:43], s46 offen offset:2048 nt
    buffer_load_dwordx4 v[252:255], v11, s[40:43], s46 offen offset:3072 nt
    s_add_u32 s46, s46, 16384
    s_mov_b32 s48, 0xaaaaaaaa
    s_mov_b32 s49, 0xaaaaaaaa
    s_mov_b32 s50, 0xcccccccc
    s_mov_b32 s51, 0xcccccccc
    s_mov_b32 s52, 0x3db504f3
    s_mov_b32 s53, 0x3fb8aa3b
    v_lshlrev_b32 v10, 5, v2
    v_mov_b32 v80, 0
    v_mov_b32 v81, 0
    v_mov_b32 v82, 0
    v_mov_b32 v83, 0
    s_barrier
    v_lshlrev_b32 v9, 4, v2
    ds_read_b128 v[12:15], v9 offset:0
    s_waitcnt lgkmcnt(0)
    s_mov_b32 s47, 0
    s_nop 1
    s_mov_b64 vcc, -1
L_ktrip:
    s_waitcnt vmcnt(4)
    s_cbranch_vccnz L_kskip0
    buffer_load_dwordx4 v[152:155], v11, s[40:43], s46 offen offset:2048 nt
    buffer_load_dwordx4 v[156:159], v11, s[40:43], s46 offen offset:3072 nt
    s_add_u32 s46, s46, 16384
L_kskip0:
    v_dot2_f32_bf16 v16, v128, v12, 0
    v_dot2_f32_bf16 v17, v132, v12, 0
    v_dot2_f32_bf16 v16, v129, v13, v16
    v_dot2_f32_bf16 v17, v133, v13, v17
    v_dot2_f32_bf16 v16, v130, v14, v16
    v_dot2_f32_bf16 v17, v134, v14, v17
    v_dot2_f32_bf16 v16, v131, v15, v16
    v_dot2_f32_bf16 v17, v135, v15, v17
    s_waitcnt vmcnt(4)
    s_cbranch_vccnz L_kskip2
    buffer_load_dwordx4 v[160:163], v11, s[40:43], s46 offen offset:0 nt
    buffer_load_dwordx4 v[164:167], v11, s[40:43], s46 offen offset:1024 nt
L_kskip2:
    v_dot2_f32_bf16 v18, v136, v12, 0
    v_dot2_f32_bf16 v19, v140, v12, 0
    v_dot2_f32_bf16 v18, v137, v13, v18
    v_dot2_f32_bf16 v19, v141, v13, v19
    v_dot2_f32_bf16 v18, v138, v14, v18
    v_dot2_f32_bf16 v19, v142, v14, v19
    v_dot2_f32_bf16 v18, v139, v15, v18
    v_dot2_f32_bf16 v19, v143, v15, v19
    s_waitcnt vmcnt(4)
    s_cbranch_vccnz L_kskip4
    buffer_load_dwordx4 v[168:171], v11, s[40:43], s46 offen offset:2048 nt
    buffer_load_dwordx4 v[172:175], v11, s[40:43], s46 offen offset:3072 nt
    s_add_u32 s46, s46, 16384
L_kskip4:
    v_dot2_f32_bf16 v20, v144, v12, 0
    v_dot2_f32_bf16 v21, v148, v12, 0
    v_dot2_f32_bf16 v20, v145, v13, v20
    v_dot2_f32_bf16 v21, v149, v13, v21
    v_dot2_f32_bf16 v20, v146, v14, v20
    v_dot2_f32_bf16 v21, v150, v14, v21
    v_dot2_f32_bf16 v20, v147, v15, v20
    v_dot2_f32_bf16 v21, v151, v15, v21
    s_waitcnt vmcnt(4)
    s_cbranch_vccnz L_kskip6
    buffer_load_dwordx4 v[176:179], v11, s[40:43], s46 offen offset:0 nt
    buffer_load_dwordx4 v[180:183], v11, s[40:43], s46 offen offset:1024 nt
L_kskip6:
    v_dot2_f32_bf16 v22, v152, v12, 0
    v_dot2_f32_bf16 v23, v156, v12, 0
    v_dot2_f32_bf16 v22, v153, v13, v22
    v_dot2_f32_bf16 v23, v157, v13, v23
    v_dot2_f32_bf16 v22, v154, v14, v22
    v_dot2_f32_bf16 v23, v158, v14, v23
    v_dot2_f32_bf16 v22, v155, v15, v22
    v_dot2_f32_bf16 v23, v159, v15, v23
    s_waitcnt vmcnt(4)
    s_cbranch_vccnz L_kskip8
    buffer_load_dwordx4 v[184:187], v11, s[40:43], s46 offen offset:2048 nt
    buffer_load_dwordx4 v[188:191], v11, s[40:43], s46 offen offset:3072 nt
    s_add_u32 s46, s46, 16384
L_kskip8:
    v_dot2_f32_bf16 v24, v160, v12, 0
    v_dot2_f32_bf16 v25, v164, v12, 0
    v_dot2_f32_bf16 v24, v161, v13, v24
    v_dot2_f32_bf16 v25, v165, v13, v25
    v_dot2_f32_bf16 v24, v162, v14, v24
    v_dot2_f32_bf16 v25, v166, v14, v25
    v_dot2_f32_bf16 v24, v163, v15, v24
    v_dot2_f32_bf16 v25, v167, v15, v25
    s_waitcnt vmcnt(4)
    s_cbranch_vccnz L_kskip10
    buffer_load_dwordx4 v[192:195], v11, s[40:43], s46 offen offset:0 nt
    buffer_load_dwordx4 v[196:199], v11, s[40:43], s46 offen offset:1024 nt
L_kskip10:
    v_dot2_f32_bf16 v26, v168, v12, 0
    v_dot2_f32_bf16 v27, v172, v12, 0
    v_dot2_f32_bf16 v26, v169, v13, v26
    v_dot2_f32_bf16 v27, v173, v13, v27
    v_dot2_f32_bf16 v26, v170, v14, v26
    v_dot2_f32_bf16 v27, v174, v14, v27
    v_dot2_f32_bf16 v26, v171, v15, v26
    v_dot2_f32_bf16 v27, v175, v15, v27
    s_waitcnt vmcnt(4)
    s_cbranch_vccnz L_kskip12
    buffer_load_dwordx4 v[200:203], v11, s[40:43], s46 offen offset:2048 nt
    buffer_load_dwordx4 v[204:207], v11, s[40:43], s46 offen offset:3072 nt
    s_add_u32 s46, s46, 16384
L_kskip12:
    v_dot2_f32_bf16 v28, v176, v12, 0
    v_dot2_f32_bf16 v29, v180, v12, 0
    v_dot2_f32_bf16 v28, v177, v13, v28
    v_dot2_f32_bf16 v29, v181, v13, v29
    v_dot2_f32_bf16 v28, v178, v14, v28
    v_dot2_f32_bf16 v29, v182, v14, v29
    v_dot2_f32_bf16 v28, v179, v15, v28
    v_dot2_f32_bf16 v29, v183, v15, v29
    s_waitcnt vmcnt(4)
    s_cbranch_vccnz L_kskip14
    buffer_load_dwordx4 v[208:211], v11, s[40:43], s46 offen offset:0 nt
    buffer_load_dwordx4 v[212:215], v11, s[40:43], s46 offen offset:1024 nt
L_kskip14:
    v_dot2_f32_bf16 v30, v184, v12, 0
    v_dot2_f32_bf16 v31, v188, v12, 0
    v_dot2_f32_bf16 v30, v185, v13, v30
    v_dot2_f32_bf16 v31, v189, v13, v31
    v_dot2_f32_bf16 v30, v186, v14, v30
    v_dot2_f32_bf16 v31, v190, v14, v31
    v_dot2_f32_bf16 v30, v187, v15, v30
    v_dot2_f32_bf16 v31, v191, v15, v31
    s_nop 2
    v_add_f32_dpp v16, v16, v16 row_ror:8 row_mask:0xf bank_mask:0x3
    v_add_f32_dpp v17, v17, v17 row_ror:8 row_mask:0xf bank_mask:0x3
    v_add_f32_dpp v18, v18, v18 row_ror:8 row_mask:0xf bank_mask:0x3
    v_add_f32_dpp v19, v19, v19 row_ror:8 row_mask:0xf bank_mask:0x3
    v_add_f32_dpp v20, v20, v20 row_ror:8 row_mask:0xf bank_mask:0x3
    v_add_f32_dpp v21, v21, v21 row_ror:8 row_mask:0xf bank_mask:0x3
    v_add_f32_dpp v22, v22, v22 row_ror:8 row_mask:0xf bank_mask:0x3
    v_add_f32_dpp v23, v23, v23 row_ror:8 row_mask:0xf bank_mask:0x3
    v_add_f32_dpp v16, v24, v24 row_ror:8 row_mask:0xf bank_mask:0xc
    v_add_f32_dpp v17, v25, v25 row_ror:8 row_mask:0xf bank_mask:0xc
    v_add_f32_dpp v18, v26, v26 row_ror:8 row_mask:0xf bank_mask:0xc
    v_add_f32_dpp v19, v27, v27 row_ror:8 row_mask:0xf bank_mask:0xc
    v_add_f32_dpp v20, v28, v28 row_ror:8 row_mask:0xf bank_mask:0xc
    v_add_f32_dpp v21, v29, v29 row_ror:8 row_mask:0xf bank_mask:0xc
    v_add_f32_dpp v22, v30, v30 row_ror:8 row_mask:0xf bank_mask:0xc
    v_add_f32_dpp v23, v31, v31 row_ror:8 row_mask:0xf bank_mask:0xc
    v_add_f32_dpp v16, v16, v16 row_half_mirror row_mask:0xf bank_mask:0x5
    v_add_f32_dpp v17, v17, v17 row_half_mirror row_mask:0xf bank_mask:0x5
    v_add_f32_dpp v18, v18, v18 row_half_mirror row_mask:0xf bank_mask:0x5
    v_add_f32_dpp v19, v19, v19 row_half_mirror row_mask:0xf bank_mask:0x5
    v_add_f32_dpp v16, v20, v20 row_half_mirror row_mask:0xf bank_mask:0xa
    v_add_f32_dpp v17, v21, v21 row_half_mirror row_mask:0xf bank_mask:0xa
    v_add_f32_dpp v18, v22, v22 row_half_mirror row_mask:0xf bank_mask:0xa
    v_add_f32_dpp v19, v23, v23 row_half_mirror row_mask:0xf bank_mask:0xa
    v_cndmask_b32_e64 v84, v18, v16, s[50:51]
    v_cndmask_b32_e64 v86, v16, v18, s[50:51]
    v_cndmask_b32_e64 v85, v19, v17, s[50:51]
    v_cndmask_b32_e64 v87, v17, v19, s[50:51]
    s_nop 0
    v_add_f32_dpp v86, v84, v86 quad_perm:[2,3,0,1] row_mask:0xf bank_mask:0xf
    v_add_f32_dpp v87, v85, v87 quad_perm:[2,3,0,1] row_mask:0xf bank_mask:0xf
    v_cndmask_b32_e64 v84, v87, v86, s[48:49]
    v_cndmask_b32_e64 v85, v86, v87, s[48:49]
    s_nop 1
    v_add_f32_dpp v85, v84, v85 quad_perm:[1,0,3,2] row_mask:0xf bank_mask:0xf
    v_cvt_pk_bf16_f32 v85, v85, v85
    v_lshlrev_b32 v85, 16, v85
    v_mul_f32 v85, s52, v85
    v_cvt_pk_bf16_f32 v85, v85, v85
    v_lshlrev_b32 v88, 16, v85
    s_waitcnt vmcnt(4)
    s_cbranch_vccnz L_kskip16
    buffer_load_dwordx4 v[216:219], v11, s[40:43], s46 offen offset:2048 nt
    buffer_load_dwordx4 v[220:223], v11, s[40:43], s46 offen offset:3072 nt
    s_add_u32 s46, s46, 16384
L_kskip16:
    v_dot2_f32_bf16 v16, v192, v12, 0
    v_dot2_f32_bf16 v17, v196, v12, 0
    v_dot2_f32_bf16 v16, v193, v13, v16
    v_dot2_f32_bf16 v17, v197, v13, v17
    v_dot2_f32_bf16 v16, v194, v14, v16
    v_dot2_f32_bf16 v17, v198, v14, v17
    v_dot2_f32_bf16 v16, v195, v15, v16
    v_dot2_f32_bf16 v17, v199, v15, v17
    s_waitcnt vmcnt(4)
    s_cbranch_vccnz L_kskip18
    buffer_load_dwordx4 v[224:227], v11, s[40:43], s46 offen offset:0 nt
    buffer_load_dwordx4 v[228:231], v11, s[40:43], s46 offen offset:1024 nt
L_kskip18:
    v_dot2_f32_bf16 v18, v200, v12, 0
    v_dot2_f32_bf16 v19, v204, v12, 0
    v_dot2_f32_bf16 v18, v201, v13, v18
    v_dot2_f32_bf16 v19, v205, v13, v19
    v_dot2_f32_bf16 v18, v202, v14, v18
    v_dot2_f32_bf16 v19, v206, v14, v19
    v_dot2_f32_bf16 v18, v203, v15, v18
    v_dot2_f32_bf16 v19, v207, v15, v19
    s_waitcnt vmcnt(4)
    s_cbranch_vccnz L_kskip20
    buffer_load_dwordx4 v[232:235], v11, s[40:43], s46 offen offset:2048 nt
    buffer_load_dwordx4 v[236:239], v11, s[40:43], s46 offen offset:3072 nt
    s_add_u32 s46, s46, 16384
L_kskip20:
    v_dot2_f32_bf16 v20, v208, v12, 0
    v_dot2_f32_bf16 v21, v212, v12, 0
    v_dot2_f32_bf16 v20, v209, v13, v20
    v_dot2_f32_bf16 v21, v213, v13, v21
    v_dot2_f32_bf16 v20, v210, v14, v20
    v_dot2_f32_bf16 v21, v214, v14, v21
    v_dot2_f32_bf16 v20, v211, v15, v20
    v_dot2_f32_bf16 v21, v215, v15, v21
    s_waitcnt vmcnt(4)
    s_cbranch_vccnz L_kskip22
    buffer_load_dwordx4 v[240:243], v11, s[40:43], s46 offen offset:0 nt
    buffer_load_dwordx4 v[244:247], v11, s[40:43], s46 offen offset:1024 nt
L_kskip22:
    v_dot2_f32_bf16 v22, v216, v12, 0
    v_dot2_f32_bf16 v23, v220, v12, 0
    v_dot2_f32_bf16 v22, v217, v13, v22
    v_dot2_f32_bf16 v23, v221, v13, v23
    v_dot2_f32_bf16 v22, v218, v14, v22
    v_dot2_f32_bf16 v23, v222, v14, v23
    v_dot2_f32_bf16 v22, v219, v15, v22
    v_dot2_f32_bf16 v23, v223, v15, v23
    s_waitcnt vmcnt(4)
    s_cbranch_vccnz L_kskip24
    buffer_load_dwordx4 v[248:251], v11, s[40:43], s46 offen offset:2048 nt
    buffer_load_dwordx4 v[252:255], v11, s[40:43], s46 offen offset:3072 nt
    s_add_u32 s46, s46, 16384
L_kskip24:
    v_dot2_f32_bf16 v24, v224, v12, 0
    v_dot2_f32_bf16 v25, v228, v12, 0
    v_dot2_f32_bf16 v24, v225, v13, v24
    v_dot2_f32_bf16 v25, v229, v13, v25
    v_dot2_f32_bf16 v24, v226, v14, v24
    v_dot2_f32_bf16 v25, v230, v14, v25
    v_dot2_f32_bf16 v24, v227, v15, v24
    v_dot2_f32_bf16 v25, v231, v15, v25
    s_cmp_lg_u32 s47, 7
    s_cbranch_scc1 L_knosw
    s_mov_b32 s40, s44
    s_mov_b32 s41, s45
    s_mov_b32 s46, 0
L_knosw:
    s_waitcnt vmcnt(4)
    buffer_load_dwordx4 v[128:131], v11, s[40:43], s46 offen offset:0 nt
    buffer_load_dwordx4 v[132:135], v11, s[40:43], s46 offen offset:1024 nt
    v_dot2_f32_bf16 v26, v232, v12, 0
    v_dot2_f32_bf16 v27, v236, v12, 0
    v_dot2_f32_bf16 v26, v233, v13, v26
    v_dot2_f32_bf16 v27, v237, v13, v27
    v_dot2_f32_bf16 v26, v234, v14, v26
    v_dot2_f32_bf16 v27, v238, v14, v27
    v_dot2_f32_bf16 v26, v235, v15, v26
    v_dot2_f32_bf16 v27, v239, v15, v27
    s_waitcnt vmcnt(4)
    buffer_load_dwordx4 v[136:139], v11, s[40:43], s46 offen offset:2048 nt
    buffer_load_dwordx4 v[140:143], v11, s[40:43], s46 offen offset:3072 nt
    s_add_u32 s46, s46, 16384
    v_dot2_f32_bf16 v28, v240, v12, 0
    v_dot2_f32_bf16 v29, v244, v12, 0
    v_dot2_f32_bf16 v28, v241, v13, v28
    v_dot2_f32_bf16 v29, v245, v13, v29
    v_dot2_f32_bf16 v28, v242, v14, v28
    v_dot2_f32_bf16 v29, v246, v14, v29
    v_dot2_f32_bf16 v28, v243, v15, v28
    v_dot2_f32_bf16 v29, v247, v15, v29
    s_waitcnt vmcnt(4)
    buffer_load_dwordx4 v[144:147], v11, s[40:43], s46 offen offset:0 nt
    buffer_load_dwordx4 v[148:151], v11, s[40:43], s46 offen offset:1024 nt
    v_dot2_f32_bf16 v30, v248, v12, 0
    v_dot2_f32_bf16 v31, v252, v12, 0
    v_dot2_f32_bf16 v30, v249, v13, v30
    v_dot2_f32_bf16 v31, v253, v13, v31
    v_dot2_f32_bf16 v30, v250, v14, v30
    v_dot2_f32_bf16 v31, v254, v14, v31
    v_dot2_f32_bf16 v30, v251, v15, v30
    v_dot2_f32_bf16 v31, v255, v15, v31
    s_nop 2
    v_add_f32_dpp v16, v16, v16 row_ror:8 row_mask:0xf bank_mask:0x3
    v_add_f32_dpp v17, v17, v17 row_ror:8 row_mask:0xf bank_mask:0x3
    v_add_f32_dpp v18, v18, v18 row_ror:8 row_mask:0xf bank_mask:0x3
    v_add_f32_dpp v19, v19, v19 row_ror:8 row_mask:0xf bank_mask:0x3
    v_add_f32_dpp v20, v20, v20 row_ror:8 row_mask:0xf bank_mask:0x3
    v_add_f32_dpp v21, v21, v21 row_ror:8 row_mask:0xf bank_mask:0x3
    v_add_f32_dpp v22, v22, v22 row_ror:8 row_mask:0xf bank_mask:0x3
    v_add_f32_dpp v23, v23, v23 row_ror:8 row_mask:0xf bank_mask:0x3
    v_add_f32_dpp v16, v24, v24 row_ror:8 row_mask:0xf bank_mask:0xc
    v_add_f32_dpp v17, v25, v25 row_ror:8 row_mask:0xf bank_mask:0xc
    v_add_f32_dpp v18, v26, v26 row_ror:8 row_mask:0xf bank_mask:0xc
    v_add_f32_dpp v19, v27, v27 row_ror:8 row_mask:0xf bank_mask:0xc
    v_add_f32_dpp v20, v28, v28 row_ror:8 row_mask:0xf bank_mask:0xc
    v_add_f32_dpp v21, v29, v29 row_ror:8 row_mask:0xf bank_mask:0xc
    v_add_f32_dpp v22, v30, v30 row_ror:8 row_mask:0xf bank_mask:0xc
    v_add_f32_dpp v23, v31, v31 row_ror:8 row_mask:0xf bank_mask:0xc
    v_add_f32_dpp v16, v16, v16 row_half_mirror row_mask:0xf bank_mask:0x5
    v_add_f32_dpp v17, v17, v17 row_half_mirror row_mask:0xf bank_mask:0x5
    v_add_f32_dpp v18, v18, v18 row_half_mirror row_mask:0xf bank_mask:0x5
    v_add_f32_dpp v19, v19, v19 row_half_mirror row_mask:0xf bank_mask:0x5
    v_add_f32_dpp v16, v20, v20 row_half_mirror row_mask:0xf bank_mask:0xa
    v_add_f32_dpp v17, v21, v21 row_half_mirror row_mask:0xf bank_mask:0xa
    v_add_f32_dpp v18, v22, v22 row_half_mirror row_mask:0xf bank_mask:0xa
    v_add_f32_dpp v19, v23, v23 row_half_mirror row_mask:0xf bank_mask:0xa
    v_cndmask_b32_e64 v84, v18, v16, s[50:51]
    v_cndmask_b32_e64 v86, v16, v18, s[50:51]
    v_cndmask_b32_e64 v85, v19, v17, s[50:51]
    v_cndmask_b32_e64 v87, v17, v19, s[50:51]
    s_nop 0
    v_add_f32_dpp v86, v84, v86 quad_perm:[2,3,0,1] row_mask:0xf bank_mask:0xf
    v_add_f32_dpp v87, v85, v87 quad_perm:[2,3,0,1] row_mask:0xf bank_mask:0xf
    v_cndmask_b32_e64 v84, v87, v86, s[48:49]
    v_cndmask_b32_e64 v85, v86, v87, s[48:49]
    s_nop 1
    v_add_f32_dpp v85, v84, v85 quad_perm:[1,0,3,2] row_mask:0xf bank_mask:0xf
    v_cvt_pk_bf16_f32 v85, v85, v85
    v_lshlrev_b32 v85, 16, v85
    v_mul_f32 v85, s52, v85
    v_cvt_pk_bf16_f32 v85, v85, v85
    v_mov_b32 v32, v34
    v_mov_b32 v33, v35
    v_mov_b32 v34, v36
    v_mov_b32 v35, v37
    v_mov_b32 v36, v38
    v_mov_b32 v37, v39
    v_mov_b32 v38, v40
    v_mov_b32 v39, v41
    v_mov_b32 v40, v42
    v_mov_b32 v41, v43
    v_mov_b32 v42, v44
    v_mov_b32 v43, v45
    v_mov_b32 v44, v46
    v_mov_b32 v45, v47
    v_mov_b32 v46, v88
    v_lshlrev_b32 v47, 16, v85
    s_mov_b64 vcc, 0
    s_add_u32 s47, s47, 1
    s_cmp_lt_u32 s47, 8
    s_cbranch_scc1 L_ktrip
    buffer_load_dwordx4 v[152:155], v11, s[40:43], s46 offen offset:2048 nt
    buffer_load_dwordx4 v[156:159], v11, s[40:43], s46 offen offset:3072 nt
    s_add_u32 s46, s46, 16384
    v_max3_f32 v84, v32, v33, v34
    v_max3_f32 v84, v84, v35, v36
    v_max3_f32 v84, v84, v37, v38
    v_max3_f32 v84, v84, v39, v40
    v_max3_f32 v84, v84, v41, v42
    v_max3_f32 v84, v84, v43, v44
    v_max3_f32 v84, v84, v45, v46
    v_max_f32 v84, v84, v47
    s_nop 1
    v_max_f32_dpp v84, v84, v84 row_ror:8 row_mask:0xf bank_mask:0xf
    s_nop 1
    v_max_f32_dpp v84, v84, v84 row_ror:4 row_mask:0xf bank_mask:0xf
    s_nop 1
    v_max_f32_dpp v84, v84, v84 row_ror:2 row_mask:0xf bank_mask:0xf
    s_nop 1
    v_max_f32_dpp v84, v84, v84 row_ror:1 row_mask:0xf bank_mask:0xf
    v_mov_b32 v86, v84
    s_nop 1
    v_permlane16_swap_b32 v84, v86
    s_nop 0
    v_max_f32 v84, v84, v86
    v_mov_b32 v86, v84
    s_nop 1
    v_permlane32_swap_b32 v84, v86
    s_nop 0
    v_max_f32 v84, v84, v86
    v_sub_f32 v32, v32, v84
    v_sub_f32 v33, v33, v84
    v_sub_f32 v34, v34, v84
    v_sub_f32 v35, v35, v84
    v_sub_f32 v36, v36, v84
    v_sub_f32 v37, v37, v84
    v_sub_f32 v38, v38, v84
    v_sub_f32 v39, v39, v84
    v_sub_f32 v40, v40, v84
    v_sub_f32 v41, v41, v84
    v_sub_f32 v42, v42, v84
    v_sub_f32 v43, v43, v84
    v_sub_f32 v44, v44, v84
    v_sub_f32 v45, v45, v84
    v_sub_f32 v46, v46, v84
    v_sub_f32 v47, v47, v84
    v_mul_f32 v32, s53, v32
    v_mul_f32 v33, s53, v33
    v_mul_f32 v34, s53, v34
    v_mul_f32 v35, s53, v35
    v_mul_f32 v36, s53, v36
    v_mul_f32 v37, s53, v37
    v_mul_f32 v38, s53, v38
    v_mul_f32 v39, s53, v39
    v_mul_f32 v40, s53, v40
    v_mul_f32 v41, s53, v41
    v_mul_f32 v42, s53, v42
    v_mul_f32 v43, s53, v43
    v_mul_f32 v44, s53, v44
    v_mul_f32 v45, s53, v45
    v_mul_f32 v46, s53, v46
    v_mul_f32 v47, s53, v47
    v_exp_f32 v32, v32
    v_exp_f32 v33, v33
    v_exp_f32 v34, v34
    v_exp_f32 v35, v35
    v_exp_f32 v36, v36
    v_exp_f32 v37, v37
    v_exp_f32 v38, v38
    v_exp_f32 v39, v39
    v_exp_f32 v40, v40
    v_exp_f32 v41, v41
    v_exp_f32 v42, v42
    v_exp_f32 v43, v43
    v_exp_f32 v44, v44
    v_exp_f32 v45, v45
    v_exp_f32 v46, v46
    v_exp_f32 v47, v47
    s_nop 0
    v_add_f32 v85, v32, v33
    v_add_f32 v85, v85, v34
    v_add_f32 v85, v85, v35
    v_add_f32 v85, v85, v36
    v_add_f32 v85, v85, v37
    v_add_f32 v85, v85, v38
    v_add_f32 v85, v85, v39
    v_add_f32 v85, v85, v40
    v_add_f32 v85, v85, v41
    v_add_f32 v85, v85, v42
    v_add_f32 v85, v85, v43
    v_add_f32 v85, v85, v44
    v_add_f32 v85, v85, v45
    v_add_f32 v85, v85, v46
    v_add_f32 v85, v85, v47
    v_cvt_pk_bf16_f32 v32, v32, v32
    v_cvt_pk_bf16_f32 v33, v33, v33
    v_cvt_pk_bf16_f32 v34, v34, v34
    v_cvt_pk_bf16_f32 v35, v35, v35
    v_cvt_pk_bf16_f32 v36, v36, v36
    v_cvt_pk_bf16_f32 v37, v37, v37
    v_cvt_pk_bf16_f32 v38, v38, v38
    v_cvt_pk_bf16_f32 v39, v39, v39
    v_cvt_pk_bf16_f32 v40, v40, v40
    v_cvt_pk_bf16_f32 v41, v41, v41
    v_cvt_pk_bf16_f32 v42, v42, v42
    v_cvt_pk_bf16_f32 v43, v43, v43
    v_cvt_pk_bf16_f32 v44, v44, v44
    v_cvt_pk_bf16_f32 v45, v45, v45
    v_cvt_pk_bf16_f32 v46, v46, v46
    v_cvt_pk_bf16_f32 v47, v47, v47
    s_nop 1
    v_add_f32_dpp v85, v85, v85 row_ror:8 row_mask:0xf bank_mask:0xf
    s_nop 1
    v_add_f32_dpp v85, v85, v85 row_ror:4 row_mask:0xf bank_mask:0xf
    s_nop 1
    v_add_f32_dpp v85, v85, v85 row_ror:2 row_mask:0xf bank_mask:0xf
    s_nop 1
    v_add_f32_dpp v85, v85, v85 row_ror:1 row_mask:0xf bank_mask:0xf
    v_mov_b32 v86, v85
    s_nop 1
    v_permlane16_swap_b32 v85, v86
    s_nop 0
    v_add_f32 v85, v85, v86
    v_mov_b32 v86, v85
    s_nop 1
    v_permlane32_swap_b32 v85, v86
    s_nop 0
    v_add_f32 v85, v85, v86
    s_lshl_b32 s35, s3, 3
    v_mov_b32 v87, s35
    ds_write_b64 v87, v[84:85] offset:2048
    s_waitcnt lgkmcnt(0)
    s_barrier
    s_mov_b32 s47, 0
    s_mov_b64 vcc, -1
L_vtrip:
    v_and_b32_dpp v64, v32, v4 row_newbcast:0 row_mask:0xf bank_mask:0xf
    v_and_b32_dpp v65, v32, v5 row_newbcast:0 row_mask:0xf bank_mask:0xf
    v_and_b32_dpp v66, v32, v6 row_newbcast:0 row_mask:0xf bank_mask:0xf
    v_and_b32_dpp v67, v32, v7 row_newbcast:0 row_mask:0xf bank_mask:0xf
    v_and_b32_dpp v68, v32, v4 row_newbcast:1 row_mask:0xf bank_mask:0xf
    v_and_b32_dpp v69, v32, v5 row_newbcast:1 row_mask:0xf bank_mask:0xf
    v_and_b32_dpp v70, v32, v6 row_newbcast:1 row_mask:0xf bank_mask:0xf
    v_and_b32_dpp v71, v32, v7 row_newbcast:1 row_mask:0xf bank_mask:0xf
    s_waitcnt vmcnt(4)
    s_cbranch_vccnz L_vtrip_skip0
    buffer_load_dwordx4 v[152:155], v11, s[40:43], s46 offen offset:2048 nt
    buffer_load_dwordx4 v[156:159], v11, s[40:43], s46 offen offset:3072 nt
    s_add_u32 s46, s46, 16384
L_vtrip_skip0:
    s_nop 0
    v_mfma_f32_16x16x32_bf16 v[80:83], v[64:67], v[128:131], v[80:83]
    v_mfma_f32_16x16x32_bf16 v[80:83], v[68:71], v[132:135], v[80:83]
    v_and_b32_dpp v64, v32, v4 row_newbcast:2 row_mask:0xf bank_mask:0xf
    v_and_b32_dpp v65, v32, v5 row_newbcast:2 row_mask:0xf bank_mask:0xf
    v_and_b32_dpp v66, v32, v6 row_newbcast:2 row_mask:0xf bank_mask:0xf
    v_and_b32_dpp v67, v32, v7 row_newbcast:2 row_mask:0xf bank_mask:0xf
    v_and_b32_dpp v68, v32, v4 row_newbcast:3 row_mask:0xf bank_mask:0xf
    v_and_b32_dpp v69, v32, v5 row_newbcast:3 row_mask:0xf bank_mask:0xf
    v_and_b32_dpp v70, v32, v6 row_newbcast:3 row_mask:0xf bank_mask:0xf
    v_and_b32_dpp v71, v32, v7 row_newbcast:3 row_mask:0xf bank_mask:0xf
    s_waitcnt vmcnt(4)
    buffer_load_dwordx4 v[160:163], v11, s[40:43], s46 offen offset:0 nt
    buffer_load_dwordx4 v[164:167], v11, s[40:43], s46 offen offset:1024 nt
    v_mfma_f32_16x16x32_bf16 v[80:83], v[64:67], v[136:139], v[80:83]
    v_mfma_f32_16x16x32_bf16 v[80:83], v[68:71], v[140:143], v[80:83]
    v_and_b32_dpp v64, v32, v4 row_newbcast:4 row_mask:0xf bank_mask:0xf
    v_and_b32_dpp v65, v32, v5 row_newbcast:4 row_mask:0xf bank_mask:0xf
    v_and_b32_dpp v66, v32, v6 row_newbcast:4 row_mask:0xf bank_mask:0xf
    v_and_b32_dpp v67, v32, v7 row_newbcast:4 row_mask:0xf bank_mask:0xf
    v_and_b32_dpp v68, v32, v4 row_newbcast:5 row_mask:0xf bank_mask:0xf
    v_and_b32_dpp v69, v32, v5 row_newbcast:5 row_mask:0xf bank_mask:0xf
    v_and_b32_dpp v70, v32, v6 row_newbcast:5 row_mask:0xf bank_mask:0xf
    v_and_b32_dpp v71, v32, v7 row_newbcast:5 row_mask:0xf bank_mask:0xf
    s_waitcnt vmcnt(4)
    buffer_load_dwordx4 v[168:171], v11, s[40:43], s46 offen offset:2048 nt
    buffer_load_dwordx4 v[172:175], v11, s[40:43], s46 offen offset:3072 nt
    s_add_u32 s46, s46, 16384
    v_mfma_f32_16x16x32_bf16 v[80:83], v[64:67], v[144:147], v[80:83]
    v_mfma_f32_16x16x32_bf16 v[80:83], v[68:71], v[148:151], v[80:83]
    v_and_b32_dpp v64, v32, v4 row_newbcast:6 row_mask:0xf bank_mask:0xf
    v_and_b32_dpp v65, v32, v5 row_newbcast:6 row_mask:0xf bank_mask:0xf
    v_and_b32_dpp v66, v32, v6 row_newbcast:6 row_mask:0xf bank_mask:0xf
    v_and_b32_dpp v67, v32, v7 row_newbcast:6 row_mask:0xf bank_mask:0xf
    v_and_b32_dpp v68, v32, v4 row_newbcast:7 row_mask:0xf bank_mask:0xf
    v_and_b32_dpp v69, v32, v5 row_newbcast:7 row_mask:0xf bank_mask:0xf
    v_and_b32_dpp v70, v32, v6 row_newbcast:7 row_mask:0xf bank_mask:0xf
    v_and_b32_dpp v71, v32, v7 row_newbcast:7 row_mask:0xf bank_mask:0xf
    s_waitcnt vmcnt(4)
    buffer_load_dwordx4 v[176:179], v11, s[40:43], s46 offen offset:0 nt
    buffer_load_dwordx4 v[180:183], v11, s[40:43], s46 offen offset:1024 nt
    v_mfma_f32_16x16x32_bf16 v[80:83], v[64:67], v[152:155], v[80:83]
    v_mfma_f32_16x16x32_bf16 v[80:83], v[68:71], v[156:159], v[80:83]
    v_and_b32_dpp v64, v32, v4 row_newbcast:8 row_mask:0xf bank_mask:0xf
    v_and_b32_dpp v65, v32, v5 row_newbcast:8 row_mask:0xf bank_mask:0xf
    v_and_b32_dpp v66, v32, v6 row_newbcast:8 row_mask:0xf bank_mask:0xf
    v_and_b32_dpp v67, v32, v7 row_newbcast:8 row_mask:0xf bank_mask:0xf
    v_and_b32_dpp v68, v32, v4 row_newbcast:9 row_mask:0xf bank_mask:0xf
    v_and_b32_dpp v69, v32, v5 row_newbcast:9 row_mask:0xf bank_mask:0xf
    v_and_b32_dpp v70, v32, v6 row_newbcast:9 row_mask:0xf bank_mask:0xf
    v_and_b32_dpp v71, v32, v7 row_newbcast:9 row_mask:0xf bank_mask:0xf
    s_waitcnt vmcnt(4)
    buffer_load_dwordx4 v[184:187], v11, s[40:43], s46 offen offset:2048 nt
    buffer_load_dwordx4 v[188:191], v11, s[40:43], s46 offen offset:3072 nt
    s_add_u32 s46, s46, 16384
    v_mfma_f32_16x16x32_bf16 v[80:83], v[64:67], v[160:163], v[80:83]
    v_mfma_f32_16x16x32_bf16 v[80:83], v[68:71], v[164:167], v[80:83]
    v_and_b32_dpp v64, v32, v4 row_newbcast:10 row_mask:0xf bank_mask:0xf
    v_and_b32_dpp v65, v32, v5 row_newbcast:10 row_mask:0xf bank_mask:0xf
    v_and_b32_dpp v66, v32, v6 row_newbcast:10 row_mask:0xf bank_mask:0xf
    v_and_b32_dpp v67, v32, v7 row_newbcast:10 row_mask:0xf bank_mask:0xf
    v_and_b32_dpp v68, v32, v4 row_newbcast:11 row_mask:0xf bank_mask:0xf
    v_and_b32_dpp v69, v32, v5 row_newbcast:11 row_mask:0xf bank_mask:0xf
    v_and_b32_dpp v70, v32, v6 row_newbcast:11 row_mask:0xf bank_mask:0xf
    v_and_b32_dpp v71, v32, v7 row_newbcast:11 row_mask:0xf bank_mask:0xf
    s_waitcnt vmcnt(4)
    buffer_load_dwordx4 v[192:195], v11, s[40:43], s46 offen offset:0 nt
    buffer_load_dwordx4 v[196:199], v11, s[40:43], s46 offen offset:1024 nt
    v_mfma_f32_16x16x32_bf16 v[80:83], v[64:67], v[168:171], v[80:83]
    v_mfma_f32_16x16x32_bf16 v[80:83], v[68:71], v[172:175], v[80:83]
    v_and_b32_dpp v64, v32, v4 row_newbcast:12 row_mask:0xf bank_mask:0xf
    v_and_b32_dpp v65, v32, v5 row_newbcast:12 row_mask:0xf bank_mask:0xf
    v_and_b32_dpp v66, v32, v6 row_newbcast:12 row_mask:0xf bank_mask:0xf
    v_and_b32_dpp v67, v32, v7 row_newbcast:12 row_mask:0xf bank_mask:0xf
    v_and_b32_dpp v68, v32, v4 row_newbcast:13 row_mask:0xf bank_mask:0xf
    v_and_b32_dpp v69, v32, v5 row_newbcast:13 row_mask:0xf bank_mask:0xf
    v_and_b32_dpp v70, v32, v6 row_newbcast:13 row_mask:0xf bank_mask:0xf
    v_and_b32_dpp v71, v32, v7 row_newbcast:13 row_mask:0xf bank_mask:0xf
    s_waitcnt vmcnt(4)
    buffer_load_dwordx4 v[200:203], v11, s[40:43], s46 offen offset:2048 nt
    buffer_load_dwordx4 v[204:207], v11, s[40:43], s46 offen offset:3072 nt
    s_add_u32 s46, s46, 16384
    v_mfma_f32_16x16x32_bf16 v[80:83], v[64:67], v[176:179], v[80:83]
    v_mfma_f32_16x16x32_bf16 v[80:83], v[68:71], v[180:183], v[80:83]
    v_and_b32_dpp v64, v32, v4 row_newbcast:14 row_mask:0xf bank_mask:0xf
    v_and_b32_dpp v65, v32, v5 row_newbcast:14 row_mask:0xf bank_mask:0xf
    v_and_b32_dpp v66, v32, v6 row_newbcast:14 row_mask:0xf bank_mask:0xf
    v_and_b32_dpp v67, v32, v7 row_newbcast:14 row_mask:0xf bank_mask:0xf
    v_and_b32_dpp v68, v32, v4 row_newbcast:15 row_mask:0xf bank_mask:0xf
    v_and_b32_dpp v69, v32, v5 row_newbcast:15 row_mask:0xf bank_mask:0xf
    v_and_b32_dpp v70, v32, v6 row_newbcast:15 row_mask:0xf bank_mask:0xf
    v_and_b32_dpp v71, v32, v7 row_newbcast:15 row_mask:0xf bank_mask:0xf
    s_waitcnt vmcnt(4)
    buffer_load_dwordx4 v[208:211], v11, s[40:43], s46 offen offset:0 nt
    buffer_load_dwordx4 v[212:215], v11, s[40:43], s46 offen offset:1024 nt
    v_mfma_f32_16x16x32_bf16 v[80:83], v[64:67], v[184:187], v[80:83]
    v_mfma_f32_16x16x32_bf16 v[80:83], v[68:71], v[188:191], v[80:83]
    v_and_b32_dpp v64, v33, v4 row_newbcast:0 row_mask:0xf bank_mask:0xf
    v_and_b32_dpp v65, v33, v5 row_newbcast:0 row_mask:0xf bank_mask:0xf
    v_and_b32_dpp v66, v33, v6 row_newbcast:0 row_mask:0xf bank_mask:0xf
    v_and_b32_dpp v67, v33, v7 row_newbcast:0 row_mask:0xf bank_mask:0xf
    v_and_b32_dpp v68, v33, v4 row_newbcast:1 row_mask:0xf bank_mask:0xf
    v_and_b32_dpp v69, v33, v5 row_newbcast:1 row_mask:0xf bank_mask:0xf
    v_and_b32_dpp v70, v33, v6 row_newbcast:1 row_mask:0xf bank_mask:0xf
    v_and_b32_dpp v71, v33, v7 row_newbcast:1 row_mask:0xf bank_mask:0xf
    s_waitcnt vmcnt(4)
    buffer_load_dwordx4 v[216:219], v11, s[40:43], s46 offen offset:2048 nt
    buffer_load_dwordx4 v[220:223], v11, s[40:43], s46 offen offset:3072 nt
    s_add_u32 s46, s46, 16384
    v_mfma_f32_16x16x32_bf16 v[80:83], v[64:67], v[192:195], v[80:83]
    v_mfma_f32_16x16x32_bf16 v[80:83], v[68:71], v[196:199], v[80:83]
    v_and_b32_dpp v64, v33, v4 row_newbcast:2 row_mask:0xf bank_mask:0xf
    v_and_b32_dpp v65, v33, v5 row_newbcast:2 row_mask:0xf bank_mask:0xf
    v_and_b32_dpp v66, v33, v6 row_newbcast:2 row_mask:0xf bank_mask:0xf
    v_and_b32_dpp v67, v33, v7 row_newbcast:2 row_mask:0xf bank_mask:0xf
    v_and_b32_dpp v68, v33, v4 row_newbcast:3 row_mask:0xf bank_mask:0xf
    v_and_b32_dpp v69, v33, v5 row_newbcast:3 row_mask:0xf bank_mask:0xf
    v_and_b32_dpp v70, v33, v6 row_newbcast:3 row_mask:0xf bank_mask:0xf
    v_and_b32_dpp v71, v33, v7 row_newbcast:3 row_mask:0xf bank_mask:0xf
    s_waitcnt vmcnt(4)
    buffer_load_dwordx4 v[224:227], v11, s[40:43], s46 offen offset:0 nt
    buffer_load_dwordx4 v[228:231], v11, s[40:43], s46 offen offset:1024 nt
    v_mfma_f32_16x16x32_bf16 v[80:83], v[64:67], v[200:203], v[80:83]
    v_mfma_f32_16x16x32_bf16 v[80:83], v[68:71], v[204:207], v[80:83]
    v_and_b32_dpp v64, v33, v4 row_newbcast:4 row_mask:0xf bank_mask:0xf
    v_and_b32_dpp v65, v33, v5 row_newbcast:4 row_mask:0xf bank_mask:0xf
    v_and_b32_dpp v66, v33, v6 row_newbcast:4 row_mask:0xf bank_mask:0xf
    v_and_b32_dpp v67, v33, v7 row_newbcast:4 row_mask:0xf bank_mask:0xf
    v_and_b32_dpp v68, v33, v4 row_newbcast:5 row_mask:0xf bank_mask:0xf
    v_and_b32_dpp v69, v33, v5 row_newbcast:5 row_mask:0xf bank_mask:0xf
    v_and_b32_dpp v70, v33, v6 row_newbcast:5 row_mask:0xf bank_mask:0xf
    v_and_b32_dpp v71, v33, v7 row_newbcast:5 row_mask:0xf bank_mask:0xf
    s_waitcnt vmcnt(4)
    buffer_load_dwordx4 v[232:235], v11, s[40:43], s46 offen offset:2048 nt
    buffer_load_dwordx4 v[236:239], v11, s[40:43], s46 offen offset:3072 nt
    s_add_u32 s46, s46, 16384
    v_mfma_f32_16x16x32_bf16 v[80:83], v[64:67], v[208:211], v[80:83]
    v_mfma_f32_16x16x32_bf16 v[80:83], v[68:71], v[212:215], v[80:83]
    v_and_b32_dpp v64, v33, v4 row_newbcast:6 row_mask:0xf bank_mask:0xf
    v_and_b32_dpp v65, v33, v5 row_newbcast:6 row_mask:0xf bank_mask:0xf
    v_and_b32_dpp v66, v33, v6 row_newbcast:6 row_mask:0xf bank_mask:0xf
    v_and_b32_dpp v67, v33, v7 row_newbcast:6 row_mask:0xf bank_mask:0xf
    v_and_b32_dpp v68, v33, v4 row_newbcast:7 row_mask:0xf bank_mask:0xf
    v_and_b32_dpp v69, v33, v5 row_newbcast:7 row_mask:0xf bank_mask:0xf
    v_and_b32_dpp v70, v33, v6 row_newbcast:7 row_mask:0xf bank_mask:0xf
    v_and_b32_dpp v71, v33, v7 row_newbcast:7 row_mask:0xf bank_mask:0xf
    s_waitcnt vmcnt(4)
    buffer_load_dwordx4 v[240:243], v11, s[40:43], s46 offen offset:0 nt
    buffer_load_dwordx4 v[244:247], v11, s[40:43], s46 offen offset:1024 nt
    v_mfma_f32_16x16x32_bf16 v[80:83], v[64:67], v[216:219], v[80:83]
    v_mfma_f32_16x16x32_bf16 v[80:83], v[68:71], v[220:223], v[80:83]
    v_and_b32_dpp v64, v33, v4 row_newbcast:8 row_mask:0xf bank_mask:0xf
    v_and_b32_dpp v65, v33, v5 row_newbcast:8 row_mask:0xf bank_mask:0xf
    v_and_b32_dpp v66, v33, v6 row_newbcast:8 row_mask:0xf bank_mask:0xf
    v_and_b32_dpp v67, v33, v7 row_newbcast:8 row_mask:0xf bank_mask:0xf
    v_and_b32_dpp v68, v33, v4 row_newbcast:9 row_mask:0xf bank_mask:0xf
    v_and_b32_dpp v69, v33, v5 row_newbcast:9 row_mask:0xf bank_mask:0xf
    v_and_b32_dpp v70, v33, v6 row_newbcast:9 row_mask:0xf bank_mask:0xf
    v_and_b32_dpp v71, v33, v7 row_newbcast:9 row_mask:0xf bank_mask:0xf
    s_waitcnt vmcnt(4)
    buffer_load_dwordx4 v[248:251], v11, s[40:43], s46 offen offset:2048 nt
    buffer_load_dwordx4 v[252:255], v11, s[40:43], s46 offen offset:3072 nt
    s_add_u32 s46, s46, 16384
    v_mfma_f32_16x16x32_bf16 v[80:83], v[64:67], v[224:227], v[80:83]
    v_mfma_f32_16x16x32_bf16 v[80:83], v[68:71], v[228:231], v[80:83]
    v_and_b32_dpp v64, v33, v4 row_newbcast:10 row_mask:0xf bank_mask:0xf
    v_and_b32_dpp v65, v33, v5 row_newbcast:10 row_mask:0xf bank_mask:0xf
    v_and_b32_dpp v66, v33, v6 row_newbcast:10 row_mask:0xf bank_mask:0xf
    v_and_b32_dpp v67, v33, v7 row_newbcast:10 row_mask:0xf bank_mask:0xf
    v_and_b32_dpp v68, v33, v4 row_newbcast:11 row_mask:0xf bank_mask:0xf
    v_and_b32_dpp v69, v33, v5 row_newbcast:11 row_mask:0xf bank_mask:0xf
    v_and_b32_dpp v70, v33, v6 row_newbcast:11 row_mask:0xf bank_mask:0xf
    v_and_b32_dpp v71, v33, v7 row_newbcast:11 row_mask:0xf bank_mask:0xf
    s_waitcnt vmcnt(4)
    buffer_load_dwordx4 v[128:131], v11, s[40:43], s46 offen offset:0 nt
    buffer_load_dwordx4 v[132:135], v11, s[40:43], s46 offen offset:1024 nt
    v_mfma_f32_16x16x32_bf16 v[80:83], v[64:67], v[232:235], v[80:83]
    v_mfma_f32_16x16x32_bf16 v[80:83], v[68:71], v[236:239], v[80:83]
    v_and_b32_dpp v64, v33, v4 row_newbcast:12 row_mask:0xf bank_mask:0xf
    v_and_b32_dpp v65, v33, v5 row_newbcast:12 row_mask:0xf bank_mask:0xf
    v_and_b32_dpp v66, v33, v6 row_newbcast:12 row_mask:0xf bank_mask:0xf
    v_and_b32_dpp v67, v33, v7 row_newbcast:12 row_mask:0xf bank_mask:0xf
    v_and_b32_dpp v68, v33, v4 row_newbcast:13 row_mask:0xf bank_mask:0xf
    v_and_b32_dpp v69, v33, v5 row_newbcast:13 row_mask:0xf bank_mask:0xf
    v_and_b32_dpp v70, v33, v6 row_newbcast:13 row_mask:0xf bank_mask:0xf
    v_and_b32_dpp v71, v33, v7 row_newbcast:13 row_mask:0xf bank_mask:0xf
    s_waitcnt vmcnt(4)
    buffer_load_dwordx4 v[136:139], v11, s[40:43], s46 offen offset:2048 nt
    buffer_load_dwordx4 v[140:143], v11, s[40:43], s46 offen offset:3072 nt
    s_add_u32 s46, s46, 16384
    v_mfma_f32_16x16x32_bf16 v[80:83], v[64:67], v[240:243], v[80:83]
    v_mfma_f32_16x16x32_bf16 v[80:83], v[68:71], v[244:247], v[80:83]
    v_and_b32_dpp v64, v33, v4 row_newbcast:14 row_mask:0xf bank_mask:0xf
    v_and_b32_dpp v65, v33, v5 row_newbcast:14 row_mask:0xf bank_mask:0xf
    v_and_b32_dpp v66, v33, v6 row_newbcast:14 row_mask:0xf bank_mask:0xf
    v_and_b32_dpp v67, v33, v7 row_newbcast:14 row_mask:0xf bank_mask:0xf
    v_and_b32_dpp v68, v33, v4 row_newbcast:15 row_mask:0xf bank_mask:0xf
    v_and_b32_dpp v69, v33, v5 row_newbcast:15 row_mask:0xf bank_mask:0xf
    v_and_b32_dpp v70, v33, v6 row_newbcast:15 row_mask:0xf bank_mask:0xf
    v_and_b32_dpp v71, v33, v7 row_newbcast:15 row_mask:0xf bank_mask:0xf
    v_mov_b32 v32, v34
    v_mov_b32 v33, v35
    v_mov_b32 v34, v36
    v_mov_b32 v35, v37
    v_mov_b32 v36, v38
    v_mov_b32 v37, v39
    v_mov_b32 v38, v40
    v_mov_b32 v39, v41
    v_mov_b32 v40, v42
    v_mov_b32 v41, v43
    v_mov_b32 v42, v44
    v_mov_b32 v43, v45
    v_mov_b32 v44, v46
    v_mov_b32 v45, v47
    s_waitcnt vmcnt(4)
    buffer_load_dwordx4 v[144:147], v11, s[40:43], s46 offen offset:0 nt
    buffer_load_dwordx4 v[148:151], v11, s[40:43], s46 offen offset:1024 nt
    v_mfma_f32_16x16x32_bf16 v[80:83], v[64:67], v[248:251], v[80:83]
    v_mfma_f32_16x16x32_bf16 v[80:83], v[68:71], v[252:255], v[80:83]
    s_mov_b64 vcc, 0
    s_add_u32 s47, s47, 1
    s_cmp_lt_u32 s47, 8
    s_cbranch_scc1 L_vtrip
    s_lshl_b32 s35, s3, 9
    v_lshlrev_b32 v8, 4, v3
    v_add3_u32 v8, v8, v10, s35
    s_mov_b32 exec_hi, 0
    s_nop 3
    ds_write_b128 v8, v[80:83] offset:2560
    s_waitcnt lgkmcnt(0)
    s_barrier
    s_endpgm
L_service:
    s_sub_u32 s34, s3, 4
    s_mov_b32 s64, s26
    s_and_b32 s65, s27, 0xffff
    s_mov_b32 s66, 5242880
    s_mov_b32 s67, 0x20000
    s_mov_b32 s40, s4
    s_and_b32 s41, s5, 0xffff
    s_mov_b32 s42, 5120
    s_mov_b32 s43, 0x20000
    s_mov_b32 s92, 0x7060500
    s_mov_b32 s93, 0x7060501
    s_mov_b32 s94, 0x7060502
    s_mov_b32 s95, 0x7060503
    s_mov_b32 s96, 0x0c0c0400
    s_mov_b32 s97, 0x0c040100
    s_mov_b32 s98, 0x04020100
    s_cmp_eq_u32 s34, 0
    s_cbranch_scc0 L_idle
    buffer_load_dword v19, off, s[64:67], 0 offset:0 sc1
    v_lshrrev_b32 v8, 2, v2
    v_mul_u32_u24 v8, 1280, v8
    v_and_b32 v10, 3, v2
    v_lshl_add_u32 v11, v10, 2, v3
    v_lshl_add_u32 v9, v11, 1, v8
    v_lshl_add_u32 v11, v3, 2, v10
    v_lshl_add_u32 v8, v11, 4, v8
    s_lshr_b32 s80, s2, 3
    s_and_b32 s80, s80, 7
    s_and_b32 s78, s80, 1
    s_lshr_b32 s80, s80, 1
    s_mul_i32 s36, s80, 320
    buffer_load_dwordx4 v[216:219], v8, s[40:43], 0 offen offset:0
    buffer_load_dwordx4 v[220:223], v8, s[40:43], 0 offen offset:256
    buffer_load_dwordx4 v[224:227], v8, s[40:43], 0 offen offset:512
    buffer_load_dwordx4 v[228:231], v8, s[40:43], 0 offen offset:768
    buffer_load_dwordx4 v[232:235], v8, s[40:43], 0 offen offset:1024
    buffer_load_ushort v32, v9, s[40:43], s36 offen offset:0
    buffer_load_ushort v33, v9, s[40:43], s36 offen offset:32
    buffer_load_ushort v34, v9, s[40:43], s36 offen offset:64
    buffer_load_ushort v35, v9, s[40:43], s36 offen offset:96
    buffer_load_ushort v36, v9, s[40:43], s36 offen offset:128
    buffer_load_ushort v37, v9, s[40:43], s36 offen offset:160
    buffer_load_ushort v38, v9, s[40:43], s36 offen offset:192
    buffer_load_ushort v39, v9, s[40:43], s36 offen offset:224
    buffer_load_ushort v40, v9, s[40:43], s36 offen offset:256
    buffer_load_ushort v41, v9, s[40:43], s36 offen offset:288
    s_mov_b32 s44, s10
    s_and_b32 s45, s11, 0xffff
    s_mov_b32 s46, 5242880
    s_mov_b32 s47, 0x20000
    v_lshlrev_b32 v10, 13, v3
    v_lshl_add_u32 v10, v2, 3, v10
    s_mul_i32 s35, s80, 1310720
    s_lshl_b32 s36, s29, 8
    s_add_u32 s35, s35, s36
    s_lshl_b32 s36, s78, 7
    s_add_u32 s35, s35, s36
    buffer_load_dwordx2 v[96:97], v10, s[44:47], s35 offen nt
    s_add_u32 s35, s35, 32768
    buffer_load_dwordx2 v[98:99], v10, s[44:47], s35 offen nt
    s_add_u32 s35, s35, 32768
    buffer_load_dwordx2 v[100:101], v10, s[44:47], s35 offen nt
    s_add_u32 s35, s35, 32768
    buffer_load_dwordx2 v[102:103], v10, s[44:47], s35 offen nt
    s_add_u32 s35, s35, 32768
    buffer_load_dwordx2 v[104:105], v10, s[44:47], s35 offen nt
    s_add_u32 s35, s35, 32768
    buffer_load_dwordx2 v[106:107], v10, s[44:47], s35 offen nt
    s_add_u32 s35, s35, 32768
    buffer_load_dwordx2 v[108:109], v10, s[44:47], s35 offen nt
    s_add_u32 s35, s35, 32768
    buffer_load_dwordx2 v[110:111], v10, s[44:47], s35 offen nt
    s_add_u32 s35, s35, 32768
    buffer_load_dwordx2 v[112:113], v10, s[44:47], s35 offen nt
    s_add_u32 s35, s35, 32768
    buffer_load_dwordx2 v[114:115], v10, s[44:47], s35 offen nt
    s_add_u32 s35, s35, 32768
    buffer_load_dwordx2 v[116:117], v10, s[44:47], s35 offen nt
    s_add_u32 s35, s35, 32768
    buffer_load_dwordx2 v[118:119], v10, s[44:47], s35 offen nt
    s_add_u32 s35, s35, 32768
    buffer_load_dwordx2 v[120:121], v10, s[44:47], s35 offen nt
    s_add_u32 s35, s35, 32768
    buffer_load_dwordx2 v[122:123], v10, s[44:47], s35 offen nt
    s_add_u32 s35, s35, 32768
    buffer_load_dwordx2 v[124:125], v10, s[44:47], s35 offen nt
    s_add_u32 s35, s35, 32768
    buffer_load_dwordx2 v[126:127], v10, s[44:47], s35 offen nt
    s_add_u32 s35, s35, 32768
    buffer_load_dwordx2 v[128:129], v10, s[44:47], s35 offen nt
    s_add_u32 s35, s35, 32768
    buffer_load_dwordx2 v[130:131], v10, s[44:47], s35 offen nt
    s_add_u32 s35, s35, 32768
    buffer_load_dwordx2 v[132:133], v10, s[44:47], s35 offen nt
    s_add_u32 s35, s35, 32768
    buffer_load_dwordx2 v[134:135], v10, s[44:47], s35 offen nt
    s_add_u32 s35, s35, 32768
    buffer_load_dwordx2 v[136:137], v10, s[44:47], s35 offen nt
    s_add_u32 s35, s35, 32768
    buffer_load_dwordx2 v[138:139], v10, s[44:47], s35 offen nt
    s_add_u32 s35, s35, 32768
    buffer_load_dwordx2 v[140:141], v10, s[44:47], s35 offen nt
    s_add_u32 s35, s35, 32768
    buffer_load_dwordx2 v[142:143], v10, s[44:47], s35 offen nt
    s_add_u32 s35, s35, 32768
    buffer_load_dwordx2 v[144:145], v10, s[44:47], s35 offen nt
    s_add_u32 s35, s35, 32768
    buffer_load_dwordx2 v[146:147], v10, s[44:47], s35 offen nt
    s_add_u32 s35, s35, 32768
    buffer_load_dwordx2 v[148:149], v10, s[44:47], s35 offen nt
    s_add_u32 s35, s35, 32768
    buffer_load_dwordx2 v[150:151], v10, s[44:47], s35 offen nt
    s_add_u32 s35, s35, 32768
    buffer_load_dwordx2 v[152:153], v10, s[44:47], s35 offen nt
    s_add_u32 s35, s35, 32768
    buffer_load_dwordx2 v[154:155], v10, s[44:47], s35 offen nt
    s_add_u32 s35, s35, 32768
    buffer_load_dwordx2 v[156:157], v10, s[44:47], s35 offen nt
    s_add_u32 s35, s35, 32768
    buffer_load_dwordx2 v[158:159], v10, s[44:47], s35 offen nt
    s_add_u32 s35, s35, 32768
    buffer_load_dwordx2 v[160:161], v10, s[44:47], s35 offen nt
    s_add_u32 s35, s35, 32768
    buffer_load_dwordx2 v[162:163], v10, s[44:47], s35 offen nt
    s_add_u32 s35, s35, 32768
    buffer_load_dwordx2 v[164:165], v10, s[44:47], s35 offen nt
    s_add_u32 s35, s35, 32768
    buffer_load_dwordx2 v[166:167], v10, s[44:47], s35 offen nt
    s_add_u32 s35, s35, 32768
    buffer_load_dwordx2 v[168:169], v10, s[44:47], s35 offen nt
    s_add_u32 s35, s35, 32768
    buffer_load_dwordx2 v[170:171], v10, s[44:47], s35 offen nt
    s_add_u32 s35, s35, 32768
    buffer_load_dwordx2 v[172:173], v10, s[44:47], s35 offen nt
    s_add_u32 s35, s35, 32768
    buffer_load_dwordx2 v[174:175], v10, s[44:47], s35 offen nt
    s_barrier
    s_lshl_b32 s81, s29, 13
    s_lshl_b32 s36, s80, 10
    s_add_u32 s81, s81, s36
    s_lshl_b32 s36, s78, 12
    s_add_u32 s81, s81, s36
    s_add_u32 s81, s81, 1441792
    v_and_b32 v8, 1, v2
    v_lshlrev_b32 v8, 4, v8
    v_mov_b32 v9, 0xffff
    v_lshlrev_b32 v9, v8, v9
    v_and_b32 v10, 2, v2
    v_cmp_eq_u32 vcc, 0, v10
    v_mov_b32 v20, 0
    v_mov_b32 v21, 0
    v_mov_b32 v22, 0
    v_mov_b32 v23, 0
    v_mov_b32 v24, 0
    v_mov_b32 v25, 0
    v_mov_b32 v26, 0
    v_mov_b32 v27, 0
    v_cndmask_b32 v12, 0, v9, vcc
    v_cmp_ne_u32 vcc, 0, v10
    s_nop 1
    v_cndmask_b32 v13, 0, v9, vcc
    s_waitcnt vmcnt(40)
    v_lshlrev_b32 v176, 16, v216
    v_and_b32 v177, 0xffff0000, v216
    v_lshlrev_b32 v178, 16, v217
    v_and_b32 v179, 0xffff0000, v217
    v_lshlrev_b32 v180, 16, v218
    v_and_b32 v181, 0xffff0000, v218
    v_lshlrev_b32 v182, 16, v219
    v_and_b32 v183, 0xffff0000, v219
    v_lshlrev_b32 v184, 16, v220
    v_and_b32 v185, 0xffff0000, v220
    v_lshlrev_b32 v186, 16, v221
    v_and_b32 v187, 0xffff0000, v221
    v_lshlrev_b32 v188, 16, v222
    v_and_b32 v189, 0xffff0000, v222
    v_lshlrev_b32 v190, 16, v223
    v_and_b32 v191, 0xffff0000, v223
    v_lshlrev_b32 v192, 16, v224
    v_and_b32 v193, 0xffff0000, v224
    v_lshlrev_b32 v194, 16, v225
    v_and_b32 v195, 0xffff0000, v225
    v_lshlrev_b32 v196, 16, v226
    v_and_b32 v197, 0xffff0000, v226
    v_lshlrev_b32 v198, 16, v227
    v_and_b32 v199, 0xffff0000, v227
    v_lshlrev_b32 v200, 16, v228
    v_and_b32 v201, 0xffff0000, v228
    v_lshlrev_b32 v202, 16, v229
    v_and_b32 v203, 0xffff0000, v229
    v_lshlrev_b32 v204, 16, v230
    v_and_b32 v205, 0xffff0000, v230
    v_lshlrev_b32 v206, 16, v231
    v_and_b32 v207, 0xffff0000, v231
    v_lshlrev_b32 v208, 16, v232
    v_and_b32 v209, 0xffff0000, v232
    v_lshlrev_b32 v210, 16, v233
    v_and_b32 v211, 0xffff0000, v233
    v_lshlrev_b32 v212, 16, v234
    v_and_b32 v213, 0xffff0000, v234
    v_lshlrev_b32 v214, 16, v235
    v_and_b32 v215, 0xffff0000, v235
    v_readfirstlane_b32 s72, v19
    v_pk_add_f32 v[64:65], v[176:177], v[184:185]
    v_pk_add_f32 v[66:67], v[178:179], v[186:187]
    v_pk_add_f32 v[68:69], v[180:181], v[188:189]
    v_pk_add_f32 v[70:71], v[182:183], v[190:191]
    v_pk_add_f32 v[64:65], v[64:65], v[192:193]
    v_pk_add_f32 v[66:67], v[66:67], v[194:195]
    v_pk_add_f32 v[68:69], v[68:69], v[196:197]
    v_pk_add_f32 v[70:71], v[70:71], v[198:199]
    v_pk_add_f32 v[64:65], v[64:65], v[200:201]
    v_pk_add_f32 v[66:67], v[66:67], v[202:203]
    v_pk_add_f32 v[68:69], v[68:69], v[204:205]
    v_pk_add_f32 v[70:71], v[70:71], v[206:207]
    v_pk_add_f32 v[64:65], v[64:65], v[208:209]
    v_pk_add_f32 v[66:67], v[66:67], v[210:211]
    v_pk_add_f32 v[68:69], v[68:69], v[212:213]
    v_pk_add_f32 v[70:71], v[70:71], v[214:215]
    v_pk_add_f32 v[64:65], v[64:65], v[66:67]
    v_pk_add_f32 v[68:69], v[68:69], v[70:71]
    s_mul_i32 s72, s72, 1664525
    v_pk_add_f32 v[64:65], v[64:65], v[68:69]
    s_add_u32 s72, s72, 1013904223
    v_add_f32 v80, v64, v65
    s_nop 1
    v_add_f32_dpp v80, v80, v80 quad_perm:[1,0,3,2] row_mask:0xf bank_mask:0xf
    s_nop 1
    v_add_f32_dpp v80, v80, v80 quad_perm:[2,3,0,1] row_mask:0xf bank_mask:0xf
    v_mov_b32 v81, v80
    s_nop 1
    v_permlane16_swap_b32 v80, v81
    s_nop 0
    v_add_f32 v80, v80, v81
    v_mov_b32 v81, v80
    s_nop 1
    v_permlane32_swap_b32 v80, v81
    s_nop 0
    v_add_f32 v80, v80, v81
    v_mul_f32 v80, 0x3acccccd, v80
    v_mov_b32 v81, v80
    v_pk_add_f32 v[176:177], v[176:177], v[80:81] neg_lo:[0,1] neg_hi:[0,1]
    v_pk_add_f32 v[178:179], v[178:179], v[80:81] neg_lo:[0,1] neg_hi:[0,1]
    v_pk_add_f32 v[180:181], v[180:181], v[80:81] neg_lo:[0,1] neg_hi:[0,1]
    v_pk_add_f32 v[182:183], v[182:183], v[80:81] neg_lo:[0,1] neg_hi:[0,1]
    v_pk_add_f32 v[184:185], v[184:185], v[80:81] neg_lo:[0,1] neg_hi:[0,1]
    v_pk_add_f32 v[186:187], v[186:187], v[80:81] neg_lo:[0,1] neg_hi:[0,1]
    v_pk_add_f32 v[188:189], v[188:189], v[80:81] neg_lo:[0,1] neg_hi:[0,1]
    v_pk_add_f32 v[190:191], v[190:191], v[80:81] neg_lo:[0,1] neg_hi:[0,1]
    v_pk_add_f32 v[192:193], v[192:193], v[80:81] neg_lo:[0,1] neg_hi:[0,1]
    v_pk_add_f32 v[194:195], v[194:195], v[80:81] neg_lo:[0,1] neg_hi:[0,1]
    v_pk_add_f32 v[196:197], v[196:197], v[80:81] neg_lo:[0,1] neg_hi:[0,1]
    v_pk_add_f32 v[198:199], v[198:199], v[80:81] neg_lo:[0,1] neg_hi:[0,1]
    v_pk_add_f32 v[200:201], v[200:201], v[80:81] neg_lo:[0,1] neg_hi:[0,1]
    v_pk_add_f32 v[202:203], v[202:203], v[80:81] neg_lo:[0,1] neg_hi:[0,1]
    v_pk_add_f32 v[204:205], v[204:205], v[80:81] neg_lo:[0,1] neg_hi:[0,1]
    v_pk_add_f32 v[206:207], v[206:207], v[80:81] neg_lo:[0,1] neg_hi:[0,1]
    v_pk_add_f32 v[208:209], v[208:209], v[80:81] neg_lo:[0,1] neg_hi:[0,1]
    v_pk_add_f32 v[210:211], v[210:211], v[80:81] neg_lo:[0,1] neg_hi:[0,1]
    v_pk_add_f32 v[212:213], v[212:213], v[80:81] neg_lo:[0,1] neg_hi:[0,1]
    v_pk_add_f32 v[214:215], v[214:215], v[80:81] neg_lo:[0,1] neg_hi:[0,1]
    v_pk_mul_f32 v[64:65], v[176:177], v[176:177]
    v_pk_mul_f32 v[66:67], v[178:179], v[178:179]
    v_pk_mul_f32 v[68:69], v[180:181], v[180:181]
    v_pk_mul_f32 v[70:71], v[182:183], v[182:183]
    v_pk_fma_f32 v[64:65], v[184:185], v[184:185], v[64:65]
    v_pk_fma_f32 v[66:67], v[186:187], v[186:187], v[66:67]
    v_pk_fma_f32 v[68:69], v[188:189], v[188:189], v[68:69]
    v_pk_fma_f32 v[70:71], v[190:191], v[190:191], v[70:71]
    v_pk_fma_f32 v[64:65], v[192:193], v[192:193], v[64:65]
    v_pk_fma_f32 v[66:67], v[194:195], v[194:195], v[66:67]
    v_pk_fma_f32 v[68:69], v[196:197], v[196:197], v[68:69]
    v_pk_fma_f32 v[70:71], v[198:199], v[198:199], v[70:71]
    v_pk_fma_f32 v[64:65], v[200:201], v[200:201], v[64:65]
    v_pk_fma_f32 v[66:67], v[202:203], v[202:203], v[66:67]
    v_pk_fma_f32 v[68:69], v[204:205], v[204:205], v[68:69]
    v_pk_fma_f32 v[70:71], v[206:207], v[206:207], v[70:71]
    v_pk_fma_f32 v[64:65], v[208:209], v[208:209], v[64:65]
    v_pk_fma_f32 v[66:67], v[210:211], v[210:211], v[66:67]
    v_pk_fma_f32 v[68:69], v[212:213], v[212:213], v[68:69]
    v_pk_fma_f32 v[70:71], v[214:215], v[214:215], v[70:71]
    v_pk_add_f32 v[64:65], v[64:65], v[66:67]
    v_pk_add_f32 v[68:69], v[68:69], v[70:71]
    v_pk_add_f32 v[64:65], v[64:65], v[68:69]
    v_add_f32 v81, v64, v65
    s_nop 1
    v_add_f32_dpp v81, v81, v81 quad_perm:[1,0,3,2] row_mask:0xf bank_mask:0xf
    s_nop 1
    v_add_f32_dpp v81, v81, v81 quad_perm:[2,3,0,1] row_mask:0xf bank_mask:0xf
    v_mov_b32 v82, v81
    s_nop 1
    v_permlane16_swap_b32 v81, v82
    s_nop 0
    v_add_f32 v81, v81, v82
    v_mov_b32 v82, v81
    s_nop 1
    v_permlane32_swap_b32 v81, v82
    s_nop 0
    v_add_f32 v81, v81, v82
    v_mul_f32 v81, 0x3acccccd, v81
    v_cvt_pk_bf16_f32 v80, v80, v80
    v_cvt_pk_bf16_f32 v81, v81, v81
    v_lshlrev_b32 v80, 16, v80
    v_lshlrev_b32 v81, 16, v81
    v_add_f32 v81, 0x3727c5ac, v81
    v_cvt_pk_bf16_f32 v81, v81, v81
    v_lshlrev_b32 v81, 16, v81
    v_sqrt_f32 v81, v81
    v_lshlrev_b32 v32, 16, v32
    v_lshlrev_b32 v33, 16, v33
    v_lshlrev_b32 v34, 16, v34
    v_lshlrev_b32 v35, 16, v35
    v_lshlrev_b32 v36, 16, v36
    v_lshlrev_b32 v37, 16, v37
    v_lshlrev_b32 v38, 16, v38
    v_lshlrev_b32 v39, 16, v39
    v_lshlrev_b32 v40, 16, v40
    v_lshlrev_b32 v41, 16, v41
    v_cvt_pk_bf16_f32 v81, v81, v81
    v_lshlrev_b32 v81, 16, v81
    v_rcp_f32 v82, v81
    v_sub_f32 v32, v32, v80
    v_sub_f32 v33, v33, v80
    v_sub_f32 v34, v34, v80
    v_sub_f32 v35, v35, v80
    v_sub_f32 v36, v36, v80
    v_sub_f32 v37, v37, v80
    v_sub_f32 v38, v38, v80
    v_sub_f32 v39, v39, v80
    v_sub_f32 v40, v40, v80
    v_sub_f32 v41, v41, v80
    v_cvt_pk_bf16_f32 v32, v32, v32
    v_cvt_pk_bf16_f32 v33, v33, v33
    v_cvt_pk_bf16_f32 v34, v34, v34
    v_cvt_pk_bf16_f32 v35, v35, v35
    v_cvt_pk_bf16_f32 v36, v36, v36
    v_cvt_pk_bf16_f32 v37, v37, v37
    v_cvt_pk_bf16_f32 v38, v38, v38
    v_cvt_pk_bf16_f32 v39, v39, v39
    v_cvt_pk_bf16_f32 v40, v40, v40
    v_cvt_pk_bf16_f32 v41, v41, v41
    v_lshlrev_b32 v32, 16, v32
    v_lshlrev_b32 v33, 16, v33
    v_lshlrev_b32 v34, 16, v34
    v_lshlrev_b32 v35, 16, v35
    v_lshlrev_b32 v36, 16, v36
    v_lshlrev_b32 v37, 16, v37
    v_lshlrev_b32 v38, 16, v38
    v_lshlrev_b32 v39, 16, v39
    v_lshlrev_b32 v40, 16, v40
    v_lshlrev_b32 v41, 16, v41
    v_mul_f32 v84, v32, v82
    v_mul_f32 v85, v33, v82
    v_mul_f32 v86, v34, v82
    v_mul_f32 v87, v35, v82
    v_mul_f32 v88, v36, v82
    v_mul_f32 v89, v37, v82
    v_mul_f32 v90, v38, v82
    v_mul_f32 v91, v39, v82
    v_mul_f32 v92, v40, v82
    v_mul_f32 v93, v41, v82
    v_fma_f32 v32, -v84, v81, v32
    v_fma_f32 v33, -v85, v81, v33
    v_fma_f32 v34, -v86, v81, v34
    v_fma_f32 v35, -v87, v81, v35
    v_fma_f32 v36, -v88, v81, v36
    v_fma_f32 v37, -v89, v81, v37
    v_fma_f32 v38, -v90, v81, v38
    v_fma_f32 v39, -v91, v81, v39
    v_fma_f32 v40, -v92, v81, v40
    v_fma_f32 v41, -v93, v81, v41
    v_fma_f32 v32, v32, v82, v84
    v_fma_f32 v33, v33, v82, v85
    v_fma_f32 v34, v34, v82, v86
    v_fma_f32 v35, v35, v82, v87
    v_fma_f32 v36, v36, v82, v88
    v_fma_f32 v37, v37, v82, v89
    v_fma_f32 v38, v38, v82, v90
    v_fma_f32 v39, v39, v82, v91
    v_fma_f32 v40, v40, v82, v92
    v_fma_f32 v41, v41, v82, v93
    v_cvt_pk_bf16_f32 v32, v32, v32
    v_cvt_pk_bf16_f32 v33, v33, v33
    v_cvt_pk_bf16_f32 v34, v34, v34
    v_cvt_pk_bf16_f32 v35, v35, v35
    v_cvt_pk_bf16_f32 v36, v36, v36
    v_cvt_pk_bf16_f32 v37, v37, v37
    v_cvt_pk_bf16_f32 v38, v38, v38
    v_cvt_pk_bf16_f32 v39, v39, v39
    v_cvt_pk_bf16_f32 v40, v40, v40
    v_cvt_pk_bf16_f32 v41, v41, v41
    v_mov_b32 v83, s72
    v_lshrrev_b32 v8, 2, v2
    v_lshlrev_b32 v8, 4, v8
    ds_write_b128 v8, v[80:83] offset:256
    s_nop 1
    v_and_b32_dpp v28, v32, v12 quad_perm:[0,0,0,0] row_mask:0xf bank_mask:0xf
    v_and_b32_dpp v29, v32, v13 quad_perm:[0,0,0,0] row_mask:0xf bank_mask:0xf
    v_and_b32_dpp v30, v32, v12 quad_perm:[1,1,1,1] row_mask:0xf bank_mask:0xf
    v_and_b32_dpp v31, v32, v13 quad_perm:[1,1,1,1] row_mask:0xf bank_mask:0xf
    s_waitcnt vmcnt(38)
    v_mfma_f32_16x16x16_bf16 v[20:23], v[28:29], v[96:97], v[20:23]
    v_and_b32_dpp v28, v32, v12 quad_perm:[2,2,2,2] row_mask:0xf bank_mask:0xf
    v_and_b32_dpp v29, v32, v13 quad_perm:[2,2,2,2] row_mask:0xf bank_mask:0xf
    v_mfma_f32_16x16x16_bf16 v[24:27], v[30:31], v[98:99], v[24:27]
    v_and_b32_dpp v30, v32, v12 quad_perm:[3,3,3,3] row_mask:0xf bank_mask:0xf
    v_and_b32_dpp v31, v32, v13 quad_perm:[3,3,3,3] row_mask:0xf bank_mask:0xf
    s_waitcnt vmcnt(36)
    v_mfma_f32_16x16x16_bf16 v[20:23], v[28:29], v[100:101], v[20:23]
    v_and_b32_dpp v28, v33, v12 quad_perm:[0,0,0,0] row_mask:0xf bank_mask:0xf
    v_and_b32_dpp v29, v33, v13 quad_perm:[0,0,0,0] row_mask:0xf bank_mask:0xf
    v_mfma_f32_16x16x16_bf16 v[24:27], v[30:31], v[102:103], v[24:27]
    v_and_b32_dpp v30, v33, v12 quad_perm:[1,1,1,1] row_mask:0xf bank_mask:0xf
    v_and_b32_dpp v31, v33, v13 quad_perm:[1,1,1,1] row_mask:0xf bank_mask:0xf
    s_waitcnt vmcnt(34)
    v_mfma_f32_16x16x16_bf16 v[20:23], v[28:29], v[104:105], v[20:23]
    v_and_b32_dpp v28, v33, v12 quad_perm:[2,2,2,2] row_mask:0xf bank_mask:0xf
    v_and_b32_dpp v29, v33, v13 quad_perm:[2,2,2,2] row_mask:0xf bank_mask:0xf
    v_mfma_f32_16x16x16_bf16 v[24:27], v[30:31], v[106:107], v[24:27]
    v_and_b32_dpp v30, v33, v12 quad_perm:[3,3,3,3] row_mask:0xf bank_mask:0xf
    v_and_b32_dpp v31, v33, v13 quad_perm:[3,3,3,3] row_mask:0xf bank_mask:0xf
    s_waitcnt vmcnt(32)
    v_mfma_f32_16x16x16_bf16 v[20:23], v[28:29], v[108:109], v[20:23]
    v_and_b32_dpp v28, v34, v12 quad_perm:[0,0,0,0] row_mask:0xf bank_mask:0xf
    v_and_b32_dpp v29, v34, v13 quad_perm:[0,0,0,0] row_mask:0xf bank_mask:0xf
    v_mfma_f32_16x16x16_bf16 v[24:27], v[30:31], v[110:111], v[24:27]
    v_and_b32_dpp v30, v34, v12 quad_perm:[1,1,1,1] row_mask:0xf bank_mask:0xf
    v_and_b32_dpp v31, v34, v13 quad_perm:[1,1,1,1] row_mask:0xf bank_mask:0xf
    s_waitcnt vmcnt(30)
    v_mfma_f32_16x16x16_bf16 v[20:23], v[28:29], v[112:113], v[20:23]
    v_and_b32_dpp v28, v34, v12 quad_perm:[2,2,2,2] row_mask:0xf bank_mask:0xf
    v_and_b32_dpp v29, v34, v13 quad_perm:[2,2,2,2] row_mask:0xf bank_mask:0xf
    v_mfma_f32_16x16x16_bf16 v[24:27], v[30:31], v[114:115], v[24:27]
    v_and_b32_dpp v30, v34, v12 quad_perm:[3,3,3,3] row_mask:0xf bank_mask:0xf
    v_and_b32_dpp v31, v34, v13 quad_perm:[3,3,3,3] row_mask:0xf bank_mask:0xf
    s_waitcnt vmcnt(28)
    v_mfma_f32_16x16x16_bf16 v[20:23], v[28:29], v[116:117], v[20:23]
    v_and_b32_dpp v28, v35, v12 quad_perm:[0,0,0,0] row_mask:0xf bank_mask:0xf
    v_and_b32_dpp v29, v35, v13 quad_perm:[0,0,0,0] row_mask:0xf bank_mask:0xf
    v_mfma_f32_16x16x16_bf16 v[24:27], v[30:31], v[118:119], v[24:27]
    v_and_b32_dpp v30, v35, v12 quad_perm:[1,1,1,1] row_mask:0xf bank_mask:0xf
    v_and_b32_dpp v31, v35, v13 quad_perm:[1,1,1,1] row_mask:0xf bank_mask:0xf
    s_waitcnt vmcnt(26)
    v_mfma_f32_16x16x16_bf16 v[20:23], v[28:29], v[120:121], v[20:23]
    v_and_b32_dpp v28, v35, v12 quad_perm:[2,2,2,2] row_mask:0xf bank_mask:0xf
    v_and_b32_dpp v29, v35, v13 quad_perm:[2,2,2,2] row_mask:0xf bank_mask:0xf
    v_mfma_f32_16x16x16_bf16 v[24:27], v[30:31], v[122:123], v[24:27]
    v_and_b32_dpp v30, v35, v12 quad_perm:[3,3,3,3] row_mask:0xf bank_mask:0xf
    v_and_b32_dpp v31, v35, v13 quad_perm:[3,3,3,3] row_mask:0xf bank_mask:0xf
    s_waitcnt vmcnt(24)
    v_mfma_f32_16x16x16_bf16 v[20:23], v[28:29], v[124:125], v[20:23]
    v_and_b32_dpp v28, v36, v12 quad_perm:[0,0,0,0] row_mask:0xf bank_mask:0xf
    v_and_b32_dpp v29, v36, v13 quad_perm:[0,0,0,0] row_mask:0xf bank_mask:0xf
    v_mfma_f32_16x16x16_bf16 v[24:27], v[30:31], v[126:127], v[24:27]
    v_and_b32_dpp v30, v36, v12 quad_perm:[1,1,1,1] row_mask:0xf bank_mask:0xf
    v_and_b32_dpp v31, v36, v13 quad_perm:[1,1,1,1] row_mask:0xf bank_mask:0xf
    s_waitcnt vmcnt(22)
    v_mfma_f32_16x16x16_bf16 v[20:23], v[28:29], v[128:129], v[20:23]
    v_and_b32_dpp v28, v36, v12 quad_perm:[2,2,2,2] row_mask:0xf bank_mask:0xf
    v_and_b32_dpp v29, v36, v13 quad_perm:[2,2,2,2] row_mask:0xf bank_mask:0xf
    v_mfma_f32_16x16x16_bf16 v[24:27], v[30:31], v[130:131], v[24:27]
    v_and_b32_dpp v30, v36, v12 quad_perm:[3,3,3,3] row_mask:0xf bank_mask:0xf
    v_and_b32_dpp v31, v36, v13 quad_perm:[3,3,3,3] row_mask:0xf bank_mask:0xf
    s_waitcnt vmcnt(20)
    v_mfma_f32_16x16x16_bf16 v[20:23], v[28:29], v[132:133], v[20:23]
    v_and_b32_dpp v28, v37, v12 quad_perm:[0,0,0,0] row_mask:0xf bank_mask:0xf
    v_and_b32_dpp v29, v37, v13 quad_perm:[0,0,0,0] row_mask:0xf bank_mask:0xf
    v_mfma_f32_16x16x16_bf16 v[24:27], v[30:31], v[134:135], v[24:27]
    v_and_b32_dpp v30, v37, v12 quad_perm:[1,1,1,1] row_mask:0xf bank_mask:0xf
    v_and_b32_dpp v31, v37, v13 quad_perm:[1,1,1,1] row_mask:0xf bank_mask:0xf
    s_waitcnt vmcnt(18)
    v_mfma_f32_16x16x16_bf16 v[20:23], v[28:29], v[136:137], v[20:23]
    v_and_b32_dpp v28, v37, v12 quad_perm:[2,2,2,2] row_mask:0xf bank_mask:0xf
    v_and_b32_dpp v29, v37, v13 quad_perm:[2,2,2,2] row_mask:0xf bank_mask:0xf
    v_mfma_f32_16x16x16_bf16 v[24:27], v[30:31], v[138:139], v[24:27]
    v_and_b32_dpp v30, v37, v12 quad_perm:[3,3,3,3] row_mask:0xf bank_mask:0xf
    v_and_b32_dpp v31, v37, v13 quad_perm:[3,3,3,3] row_mask:0xf bank_mask:0xf
    s_waitcnt vmcnt(16)
    v_mfma_f32_16x16x16_bf16 v[20:23], v[28:29], v[140:141], v[20:23]
    v_and_b32_dpp v28, v38, v12 quad_perm:[0,0,0,0] row_mask:0xf bank_mask:0xf
    v_and_b32_dpp v29, v38, v13 quad_perm:[0,0,0,0] row_mask:0xf bank_mask:0xf
    v_mfma_f32_16x16x16_bf16 v[24:27], v[30:31], v[142:143], v[24:27]
    v_and_b32_dpp v30, v38, v12 quad_perm:[1,1,1,1] row_mask:0xf bank_mask:0xf
    v_and_b32_dpp v31, v38, v13 quad_perm:[1,1,1,1] row_mask:0xf bank_mask:0xf
    s_waitcnt vmcnt(14)
    v_mfma_f32_16x16x16_bf16 v[20:23], v[28:29], v[144:145], v[20:23]
    v_and_b32_dpp v28, v38, v12 quad_perm:[2,2,2,2] row_mask:0xf bank_mask:0xf
    v_and_b32_dpp v29, v38, v13 quad_perm:[2,2,2,2] row_mask:0xf bank_mask:0xf
    v_mfma_f32_16x16x16_bf16 v[24:27], v[30:31], v[146:147], v[24:27]
    v_and_b32_dpp v30, v38, v12 quad_perm:[3,3,3,3] row_mask:0xf bank_mask:0xf
    v_and_b32_dpp v31, v38, v13 quad_perm:[3,3,3,3] row_mask:0xf bank_mask:0xf
    s_waitcnt vmcnt(12)
    v_mfma_f32_16x16x16_bf16 v[20:23], v[28:29], v[148:149], v[20:23]
    v_and_b32_dpp v28, v39, v12 quad_perm:[0,0,0,0] row_mask:0xf bank_mask:0xf
    v_and_b32_dpp v29, v39, v13 quad_perm:[0,0,0,0] row_mask:0xf bank_mask:0xf
    v_mfma_f32_16x16x16_bf16 v[24:27], v[30:31], v[150:151], v[24:27]
    v_and_b32_dpp v30, v39, v12 quad_perm:[1,1,1,1] row_mask:0xf bank_mask:0xf
    v_and_b32_dpp v31, v39, v13 quad_perm:[1,1,1,1] row_mask:0xf bank_mask:0xf
    s_waitcnt vmcnt(10)
    v_mfma_f32_16x16x16_bf16 v[20:23], v[28:29], v[152:153], v[20:23]
    v_and_b32_dpp v28, v39, v12 quad_perm:[2,2,2,2] row_mask:0xf bank_mask:0xf
    v_and_b32_dpp v29, v39, v13 quad_perm:[2,2,2,2] row_mask:0xf bank_mask:0xf
    v_mfma_f32_16x16x16_bf16 v[24:27], v[30:31], v[154:155], v[24:27]
    v_and_b32_dpp v30, v39, v12 quad_perm:[3,3,3,3] row_mask:0xf bank_mask:0xf
    v_and_b32_dpp v31, v39, v13 quad_perm:[3,3,3,3] row_mask:0xf bank_mask:0xf
    s_waitcnt vmcnt(8)
    v_mfma_f32_16x16x16_bf16 v[20:23], v[28:29], v[156:157], v[20:23]
    v_and_b32_dpp v28, v40, v12 quad_perm:[0,0,0,0] row_mask:0xf bank_mask:0xf
    v_and_b32_dpp v29, v40, v13 quad_perm:[0,0,0,0] row_mask:0xf bank_mask:0xf
    v_mfma_f32_16x16x16_bf16 v[24:27], v[30:31], v[158:159], v[24:27]
    v_and_b32_dpp v30, v40, v12 quad_perm:[1,1,1,1] row_mask:0xf bank_mask:0xf
    v_and_b32_dpp v31, v40, v13 quad_perm:[1,1,1,1] row_mask:0xf bank_mask:0xf
    s_waitcnt vmcnt(6)
    v_mfma_f32_16x16x16_bf16 v[20:23], v[28:29], v[160:161], v[20:23]
    v_and_b32_dpp v28, v40, v12 quad_perm:[2,2,2,2] row_mask:0xf bank_mask:0xf
    v_and_b32_dpp v29, v40, v13 quad_perm:[2,2,2,2] row_mask:0xf bank_mask:0xf
    v_mfma_f32_16x16x16_bf16 v[24:27], v[30:31], v[162:163], v[24:27]
    v_and_b32_dpp v30, v40, v12 quad_perm:[3,3,3,3] row_mask:0xf bank_mask:0xf
    v_and_b32_dpp v31, v40, v13 quad_perm:[3,3,3,3] row_mask:0xf bank_mask:0xf
    s_waitcnt vmcnt(4)
    v_mfma_f32_16x16x16_bf16 v[20:23], v[28:29], v[164:165], v[20:23]
    v_and_b32_dpp v28, v41, v12 quad_perm:[0,0,0,0] row_mask:0xf bank_mask:0xf
    v_and_b32_dpp v29, v41, v13 quad_perm:[0,0,0,0] row_mask:0xf bank_mask:0xf
    v_mfma_f32_16x16x16_bf16 v[24:27], v[30:31], v[166:167], v[24:27]
    v_and_b32_dpp v30, v41, v12 quad_perm:[1,1,1,1] row_mask:0xf bank_mask:0xf
    v_and_b32_dpp v31, v41, v13 quad_perm:[1,1,1,1] row_mask:0xf bank_mask:0xf
    s_waitcnt vmcnt(2)
    v_mfma_f32_16x16x16_bf16 v[20:23], v[28:29], v[168:169], v[20:23]
    v_and_b32_dpp v28, v41, v12 quad_perm:[2,2,2,2] row_mask:0xf bank_mask:0xf
    v_and_b32_dpp v29, v41, v13 quad_perm:[2,2,2,2] row_mask:0xf bank_mask:0xf
    v_mfma_f32_16x16x16_bf16 v[24:27], v[30:31], v[170:171], v[24:27]
    v_and_b32_dpp v30, v41, v12 quad_perm:[3,3,3,3] row_mask:0xf bank_mask:0xf
    v_and_b32_dpp v31, v41, v13 quad_perm:[3,3,3,3] row_mask:0xf bank_mask:0xf
    s_waitcnt vmcnt(0)
    v_mfma_f32_16x16x16_bf16 v[20:23], v[28:29], v[172:173], v[20:23]
    s_nop 1
    v_mfma_f32_16x16x16_bf16 v[24:27], v[30:31], v[174:175], v[24:27]
    v_lshlrev_b32 v11, 4, v0
    v_mov_b32 v72, s72
    s_nop 9
    v_add_f32 v64, v20, v24
    v_add_f32 v65, v21, v25
    v_add_f32 v66, v22, v26
    v_add_f32 v67, v23, v27
    v_add_u32 v68, 0x80, v64
    v_add_u32 v69, 0x80, v65
    v_add_u32 v70, 0x80, v66
    v_add_u32 v71, 0x80, v67
    v_perm_b32 v68, v68, v72, s92
    v_perm_b32 v69, v69, v72, s93
    v_perm_b32 v70, v70, v72, s94
    v_perm_b32 v71, v71, v72, s95
    buffer_store_dwordx4 v[68:71], v11, s[64:67], s81 offen sc1
    v_lshlrev_b32 v10, 10, v3
    v_lshl_add_u32 v10, v2, 4, v10
    s_lshl_b32 s82, s29, 13
    s_lshl_b32 s36, s28, 8
    s_add_u32 s82, s82, s36
    s_add_u32 s82, s82, 1441792
    s_add_u32 s35, s82, 4096
    s_mov_b32 s36, 20000
    s_waitcnt vmcnt(0)
L_pollq:
    buffer_load_dwordx4 v[96:99], v10, s[64:67], s82 offen sc1 nt
    buffer_load_dwordx4 v[100:103], v10, s[64:67], s35 offen sc1 nt
    s_waitcnt vmcnt(0)
    v_perm_b32 v80, v97, v96, s96
    v_perm_b32 v80, v98, v80, s97
    v_perm_b32 v80, v99, v80, s98
    v_perm_b32 v81, v101, v100, s96
    v_perm_b32 v81, v102, v81, s97
    v_perm_b32 v81, v103, v81, s98
    v_cmp_ne_u32 vcc, s72, v80
    v_cmp_ne_u32_e64 s[74:75], s72, v81
    s_nop 1
    s_or_b64 s[74:75], vcc, s[74:75]
    s_cbranch_scc0 L_pollq_done
    s_sub_u32 s36, s36, 1
    s_cmp_lg_u32 s36, 0
    s_cbranch_scc1 L_pollq
L_pollq_done:
    v_and_b32 v96, 0xffffff00, v96
    v_and_b32 v97, 0xffffff00, v97
    v_and_b32 v98, 0xffffff00, v98
    v_and_b32 v99, 0xffffff00, v99
    v_and_b32 v100, 0xffffff00, v100
    v_and_b32 v101, 0xffffff00, v101
    v_and_b32 v102, 0xffffff00, v102
    v_and_b32 v103, 0xffffff00, v103
    v_mov_b32 v80, v96
    v_mov_b32 v81, v97
    v_mov_b32 v82, v98
    v_mov_b32 v83, v99
    v_mov_b32 v84, v100
    v_mov_b32 v85, v101
    v_mov_b32 v86, v102
    v_mov_b32 v87, v103
    s_nop 1
    v_permlane16_swap_b32 v96, v80
    v_permlane16_swap_b32 v97, v81
    v_permlane16_swap_b32 v98, v82
    v_permlane16_swap_b32 v99, v83
    v_permlane16_swap_b32 v100, v84
    v_permlane16_swap_b32 v101, v85
    v_permlane16_swap_b32 v102, v86
    v_permlane16_swap_b32 v103, v87
    s_nop 0
    v_add_f32 v96, v96, v80
    v_add_f32 v97, v97, v81
    v_add_f32 v98, v98, v82
    v_add_f32 v99, v99, v83
    v_add_f32 v100, v100, v84
    v_add_f32 v101, v101, v85
    v_add_f32 v102, v102, v86
    v_add_f32 v103, v103, v87
    v_mov_b32 v80, v96
    v_mov_b32 v81, v97
    v_mov_b32 v82, v98
    v_mov_b32 v83, v99
    v_mov_b32 v84, v100
    v_mov_b32 v85, v101
    v_mov_b32 v86, v102
    v_mov_b32 v87, v103
    s_nop 1
    v_permlane32_swap_b32 v96, v80
    v_permlane32_swap_b32 v97, v81
    v_permlane32_swap_b32 v98, v82
    v_permlane32_swap_b32 v99, v83
    v_permlane32_swap_b32 v100, v84
    v_permlane32_swap_b32 v101, v85
    v_permlane32_swap_b32 v102, v86
    v_permlane32_swap_b32 v103, v87
    s_nop 0
    v_add_f32 v96, v96, v80
    v_add_f32 v97, v97, v81
    v_add_f32 v98, v98, v82
    v_add_f32 v99, v99, v83
    v_add_f32 v100, v100, v84
    v_add_f32 v101, v101, v85
    v_add_f32 v102, v102, v86
    v_add_f32 v103, v103, v87
    v_lshlrev_b32 v9, 3, v2
    v_cvt_pk_bf16_f32 v80, v96, v97
    v_cvt_pk_bf16_f32 v81, v98, v99
    v_cvt_pk_bf16_f32 v82, v100, v101
    v_cvt_pk_bf16_f32 v83, v102, v103
    ds_write_b64 v9, v[80:81] offset:0
    ds_write_b64 v9, v[82:83] offset:128
    s_waitcnt lgkmcnt(0)
    s_branch L_b1
L_idle:
    s_barrier
L_b1:
    s_barrier
    v_lshrrev_b32 v8, 2, v2
    v_lshlrev_b32 v9, 4, v8
    ds_read_b128 v[80:83], v9 offset:256
    s_waitcnt lgkmcnt(0)
    v_readfirstlane_b32 s72, v83
    s_cmp_lg_u32 s34, 2
    s_cbranch_scc1 L_common
    s_mov_b32 s99, s2
    s_cmp_ge_u32 s99, 216
    s_cbranch_scc1 L_common
    s_cmp_ge_u32 s99, 108
    s_cselect_b32 s36, 108, 0
    s_sub_u32 s36, s99, s36
    s_and_b32 s78, s36, 3
    s_lshr_b32 s79, s36, 2
    v_mul_u32_u24 v8, 1280, v8
    v_and_b32 v10, 3, v2
    v_lshl_add_u32 v11, v10, 2, v3
    v_lshl_add_u32 v9, v11, 1, v8
    s_mul_i32 s36, s78, 320
    buffer_load_ushort v32, v9, s[40:43], s36 offen offset:0
    buffer_load_ushort v33, v9, s[40:43], s36 offen offset:32
    buffer_load_ushort v34, v9, s[40:43], s36 offen offset:64
    buffer_load_ushort v35, v9, s[40:43], s36 offen offset:96
    buffer_load_ushort v36, v9, s[40:43], s36 offen offset:128
    buffer_load_ushort v37, v9, s[40:43], s36 offen offset:160
    buffer_load_ushort v38, v9, s[40:43], s36 offen offset:192
    buffer_load_ushort v39, v9, s[40:43], s36 offen offset:224
    buffer_load_ushort v40, v9, s[40:43], s36 offen offset:256
    buffer_load_ushort v41, v9, s[40:43], s36 offen offset:288
    s_cmp_ge_u32 s99, 108
    s_cbranch_scc1 L_ldU
    s_mov_b32 s44, s16
    s_and_b32 s45, s17, 0xffff
    s_mov_b32 s46, 2211840
    s_mov_b32 s47, 0x20000
    s_branch L_ldF2
L_ldU:
    s_mov_b32 s44, s18
    s_and_b32 s45, s19, 0xffff
    s_mov_b32 s46, 2211840
    s_mov_b32 s47, 0x20000
L_ldF2:
    v_mul_u32_u24 v1, 3456, v3
    v_lshl_add_u32 v1, v2, 3, v1
    s_mul_i32 s83, s78, 552960
    s_lshl_b32 s36, s79, 7
    s_add_u32 s83, s83, s36
    buffer_load_dwordx2 v[96:97], v1, s[44:47], s83 offen nt
    s_add_u32 s83, s83, 13824
    buffer_load_dwordx2 v[98:99], v1, s[44:47], s83 offen nt
    s_add_u32 s83, s83, 13824
    buffer_load_dwordx2 v[100:101], v1, s[44:47], s83 offen nt
    s_add_u32 s83, s83, 13824
    buffer_load_dwordx2 v[102:103], v1, s[44:47], s83 offen nt
    s_add_u32 s83, s83, 13824
    buffer_load_dwordx2 v[104:105], v1, s[44:47], s83 offen nt
    s_add_u32 s83, s83, 13824
    buffer_load_dwordx2 v[106:107], v1, s[44:47], s83 offen nt
    s_add_u32 s83, s83, 13824
    buffer_load_dwordx2 v[108:109], v1, s[44:47], s83 offen nt
    s_add_u32 s83, s83, 13824
    buffer_load_dwordx2 v[110:111], v1, s[44:47], s83 offen nt
    s_add_u32 s83, s83, 13824
    buffer_load_dwordx2 v[112:113], v1, s[44:47], s83 offen nt
    s_add_u32 s83, s83, 13824
    buffer_load_dwordx2 v[114:115], v1, s[44:47], s83 offen nt
    s_add_u32 s83, s83, 13824
    buffer_load_dwordx2 v[116:117], v1, s[44:47], s83 offen nt
    s_add_u32 s83, s83, 13824
    buffer_load_dwordx2 v[118:119], v1, s[44:47], s83 offen nt
    s_add_u32 s83, s83, 13824
    buffer_load_dwordx2 v[120:121], v1, s[44:47], s83 offen nt
    s_add_u32 s83, s83, 13824
    buffer_load_dwordx2 v[122:123], v1, s[44:47], s83 offen nt
    s_add_u32 s83, s83, 13824
    buffer_load_dwordx2 v[124:125], v1, s[44:47], s83 offen nt
    s_add_u32 s83, s83, 13824
    buffer_load_dwordx2 v[126:127], v1, s[44:47], s83 offen nt
    s_add_u32 s83, s83, 13824
    buffer_load_dwordx2 v[128:129], v1, s[44:47], s83 offen nt
    s_add_u32 s83, s83, 13824
    buffer_load_dwordx2 v[130:131], v1, s[44:47], s83 offen nt
    s_add_u32 s83, s83, 13824
    buffer_load_dwordx2 v[132:133], v1, s[44:47], s83 offen nt
    s_add_u32 s83, s83, 13824
    buffer_load_dwordx2 v[134:135], v1, s[44:47], s83 offen nt
    s_add_u32 s83, s83, 13824
    buffer_load_dwordx2 v[136:137], v1, s[44:47], s83 offen nt
    s_add_u32 s83, s83, 13824
    buffer_load_dwordx2 v[138:139], v1, s[44:47], s83 offen nt
    s_add_u32 s83, s83, 13824
    buffer_load_dwordx2 v[140:141], v1, s[44:47], s83 offen nt
    s_add_u32 s83, s83, 13824
    buffer_load_dwordx2 v[142:143], v1, s[44:47], s83 offen nt
    s_add_u32 s83, s83, 13824
    buffer_load_dwordx2 v[144:145], v1, s[44:47], s83 offen nt
    s_add_u32 s83, s83, 13824
    buffer_load_dwordx2 v[146:147], v1, s[44:47], s83 offen nt
    s_add_u32 s83, s83, 13824
    buffer_load_dwordx2 v[148:149], v1, s[44:47], s83 offen nt
    s_add_u32 s83, s83, 13824
    buffer_load_dwordx2 v[150:151], v1, s[44:47], s83 offen nt
    s_add_u32 s83, s83, 13824
    buffer_load_dwordx2 v[152:153], v1, s[44:47], s83 offen nt
    s_add_u32 s83, s83, 13824
    buffer_load_dwordx2 v[154:155], v1, s[44:47], s83 offen nt
    s_add_u32 s83, s83, 13824
    buffer_load_dwordx2 v[156:157], v1, s[44:47], s83 offen nt
    s_add_u32 s83, s83, 13824
    buffer_load_dwordx2 v[158:159], v1, s[44:47], s83 offen nt
    s_add_u32 s83, s83, 13824
    buffer_load_dwordx2 v[160:161], v1, s[44:47], s83 offen nt
    s_add_u32 s83, s83, 13824
    buffer_load_dwordx2 v[162:163], v1, s[44:47], s83 offen nt
    s_add_u32 s83, s83, 13824
    buffer_load_dwordx2 v[164:165], v1, s[44:47], s83 offen nt
    s_add_u32 s83, s83, 13824
    buffer_load_dwordx2 v[166:167], v1, s[44:47], s83 offen nt
    s_add_u32 s83, s83, 13824
    buffer_load_dwordx2 v[168:169], v1, s[44:47], s83 offen nt
    s_add_u32 s83, s83, 13824
    buffer_load_dwordx2 v[170:171], v1, s[44:47], s83 offen nt
    s_add_u32 s83, s83, 13824
    buffer_load_dwordx2 v[172:173], v1, s[44:47], s83 offen nt
    s_add_u32 s83, s83, 13824
    buffer_load_dwordx2 v[174:175], v1, s[44:47], s83 offen nt
    v_and_b32 v8, 1, v2
    v_lshlrev_b32 v8, 4, v8
    v_mov_b32 v9, 0xffff
    v_lshlrev_b32 v9, v8, v9
    v_and_b32 v10, 2, v2
    v_cmp_eq_u32 vcc, 0, v10
    v_mov_b32 v20, 0
    v_mov_b32 v21, 0
    v_mov_b32 v22, 0
    v_mov_b32 v23, 0
    v_mov_b32 v24, 0
    v_mov_b32 v25, 0
    v_mov_b32 v26, 0
    v_mov_b32 v27, 0
    v_cndmask_b32 v12, 0, v9, vcc
    v_cmp_ne_u32 vcc, 0, v10
    s_nop 1
    v_cndmask_b32 v13, 0, v9, vcc
    s_waitcnt vmcnt(40)
    v_lshlrev_b32 v32, 16, v32
    v_lshlrev_b32 v33, 16, v33
    v_lshlrev_b32 v34, 16, v34
    v_lshlrev_b32 v35, 16, v35
    v_lshlrev_b32 v36, 16, v36
    v_lshlrev_b32 v37, 16, v37
    v_lshlrev_b32 v38, 16, v38
    v_lshlrev_b32 v39, 16, v39
    v_lshlrev_b32 v40, 16, v40
    v_lshlrev_b32 v41, 16, v41
    v_sub_f32 v32, v32, v80
    v_sub_f32 v33, v33, v80
    v_sub_f32 v34, v34, v80
    v_sub_f32 v35, v35, v80
    v_sub_f32 v36, v36, v80
    v_sub_f32 v37, v37, v80
    v_sub_f32 v38, v38, v80
    v_sub_f32 v39, v39, v80
    v_sub_f32 v40, v40, v80
    v_sub_f32 v41, v41, v80
    v_cvt_pk_bf16_f32 v32, v32, v32
    v_cvt_pk_bf16_f32 v33, v33, v33
    v_cvt_pk_bf16_f32 v34, v34, v34
    v_cvt_pk_bf16_f32 v35, v35, v35
    v_cvt_pk_bf16_f32 v36, v36, v36
    v_cvt_pk_bf16_f32 v37, v37, v37
    v_cvt_pk_bf16_f32 v38, v38, v38
    v_cvt_pk_bf16_f32 v39, v39, v39
    v_cvt_pk_bf16_f32 v40, v40, v40
    v_cvt_pk_bf16_f32 v41, v41, v41
    v_lshlrev_b32 v32, 16, v32
    v_lshlrev_b32 v33, 16, v33
    v_lshlrev_b32 v34, 16, v34
    v_lshlrev_b32 v35, 16, v35
    v_lshlrev_b32 v36, 16, v36
    v_lshlrev_b32 v37, 16, v37
    v_lshlrev_b32 v38, 16, v38
    v_lshlrev_b32 v39, 16, v39
    v_lshlrev_b32 v40, 16, v40
    v_lshlrev_b32 v41, 16, v41
    v_mul_f32 v84, v32, v82
    v_mul_f32 v85, v33, v82
    v_mul_f32 v86, v34, v82
    v_mul_f32 v87, v35, v82
    v_mul_f32 v88, v36, v82
    v_mul_f32 v89, v37, v82
    v_mul_f32 v90, v38, v82
    v_mul_f32 v91, v39, v82
    v_mul_f32 v92, v40, v82
    v_mul_f32 v93, v41, v82
    v_fma_f32 v32, -v84, v81, v32
    v_fma_f32 v33, -v85, v81, v33
    v_fma_f32 v34, -v86, v81, v34
    v_fma_f32 v35, -v87, v81, v35
    v_fma_f32 v36, -v88, v81, v36
    v_fma_f32 v37, -v89, v81, v37
    v_fma_f32 v38, -v90, v81, v38
    v_fma_f32 v39, -v91, v81, v39
    v_fma_f32 v40, -v92, v81, v40
    v_fma_f32 v41, -v93, v81, v41
    v_fma_f32 v32, v32, v82, v84
    v_fma_f32 v33, v33, v82, v85
    v_fma_f32 v34, v34, v82, v86
    v_fma_f32 v35, v35, v82, v87
    v_fma_f32 v36, v36, v82, v88
    v_fma_f32 v37, v37, v82, v89
    v_fma_f32 v38, v38, v82, v90
    v_fma_f32 v39, v39, v82, v91
    v_fma_f32 v40, v40, v82, v92
    v_fma_f32 v41, v41, v82, v93
    v_cvt_pk_bf16_f32 v32, v32, v32
    v_cvt_pk_bf16_f32 v33, v33, v33
    v_cvt_pk_bf16_f32 v34, v34, v34
    v_cvt_pk_bf16_f32 v35, v35, v35
    v_cvt_pk_bf16_f32 v36, v36, v36
    v_cvt_pk_bf16_f32 v37, v37, v37
    v_cvt_pk_bf16_f32 v38, v38, v38
    v_cvt_pk_bf16_f32 v39, v39, v39
    v_cvt_pk_bf16_f32 v40, v40, v40
    v_cvt_pk_bf16_f32 v41, v41, v41
    s_nop 1
    v_and_b32_dpp v28, v32, v12 quad_perm:[0,0,0,0] row_mask:0xf bank_mask:0xf
    v_and_b32_dpp v29, v32, v13 quad_perm:[0,0,0,0] row_mask:0xf bank_mask:0xf
    v_and_b32_dpp v30, v32, v12 quad_perm:[1,1,1,1] row_mask:0xf bank_mask:0xf
    v_and_b32_dpp v31, v32, v13 quad_perm:[1,1,1,1] row_mask:0xf bank_mask:0xf
    s_waitcnt vmcnt(38)
    v_mfma_f32_16x16x16_bf16 v[20:23], v[28:29], v[96:97], v[20:23]
    v_and_b32_dpp v28, v32, v12 quad_perm:[2,2,2,2] row_mask:0xf bank_mask:0xf
    v_and_b32_dpp v29, v32, v13 quad_perm:[2,2,2,2] row_mask:0xf bank_mask:0xf
    v_mfma_f32_16x16x16_bf16 v[24:27], v[30:31], v[98:99], v[24:27]
    v_and_b32_dpp v30, v32, v12 quad_perm:[3,3,3,3] row_mask:0xf bank_mask:0xf
    v_and_b32_dpp v31, v32, v13 quad_perm:[3,3,3,3] row_mask:0xf bank_mask:0xf
    s_waitcnt vmcnt(36)
    v_mfma_f32_16x16x16_bf16 v[20:23], v[28:29], v[100:101], v[20:23]
    v_and_b32_dpp v28, v33, v12 quad_perm:[0,0,0,0] row_mask:0xf bank_mask:0xf
    v_and_b32_dpp v29, v33, v13 quad_perm:[0,0,0,0] row_mask:0xf bank_mask:0xf
    v_mfma_f32_16x16x16_bf16 v[24:27], v[30:31], v[102:103], v[24:27]
    v_and_b32_dpp v30, v33, v12 quad_perm:[1,1,1,1] row_mask:0xf bank_mask:0xf
    v_and_b32_dpp v31, v33, v13 quad_perm:[1,1,1,1] row_mask:0xf bank_mask:0xf
    s_waitcnt vmcnt(34)
    v_mfma_f32_16x16x16_bf16 v[20:23], v[28:29], v[104:105], v[20:23]
    v_and_b32_dpp v28, v33, v12 quad_perm:[2,2,2,2] row_mask:0xf bank_mask:0xf
    v_and_b32_dpp v29, v33, v13 quad_perm:[2,2,2,2] row_mask:0xf bank_mask:0xf
    v_mfma_f32_16x16x16_bf16 v[24:27], v[30:31], v[106:107], v[24:27]
    v_and_b32_dpp v30, v33, v12 quad_perm:[3,3,3,3] row_mask:0xf bank_mask:0xf
    v_and_b32_dpp v31, v33, v13 quad_perm:[3,3,3,3] row_mask:0xf bank_mask:0xf
    s_waitcnt vmcnt(32)
    v_mfma_f32_16x16x16_bf16 v[20:23], v[28:29], v[108:109], v[20:23]
    v_and_b32_dpp v28, v34, v12 quad_perm:[0,0,0,0] row_mask:0xf bank_mask:0xf
    v_and_b32_dpp v29, v34, v13 quad_perm:[0,0,0,0] row_mask:0xf bank_mask:0xf
    v_mfma_f32_16x16x16_bf16 v[24:27], v[30:31], v[110:111], v[24:27]
    v_and_b32_dpp v30, v34, v12 quad_perm:[1,1,1,1] row_mask:0xf bank_mask:0xf
    v_and_b32_dpp v31, v34, v13 quad_perm:[1,1,1,1] row_mask:0xf bank_mask:0xf
    s_waitcnt vmcnt(30)
    v_mfma_f32_16x16x16_bf16 v[20:23], v[28:29], v[112:113], v[20:23]
    v_and_b32_dpp v28, v34, v12 quad_perm:[2,2,2,2] row_mask:0xf bank_mask:0xf
    v_and_b32_dpp v29, v34, v13 quad_perm:[2,2,2,2] row_mask:0xf bank_mask:0xf
    v_mfma_f32_16x16x16_bf16 v[24:27], v[30:31], v[114:115], v[24:27]
    v_and_b32_dpp v30, v34, v12 quad_perm:[3,3,3,3] row_mask:0xf bank_mask:0xf
    v_and_b32_dpp v31, v34, v13 quad_perm:[3,3,3,3] row_mask:0xf bank_mask:0xf
    s_waitcnt vmcnt(28)
    v_mfma_f32_16x16x16_bf16 v[20:23], v[28:29], v[116:117], v[20:23]
    v_and_b32_dpp v28, v35, v12 quad_perm:[0,0,0,0] row_mask:0xf bank_mask:0xf
    v_and_b32_dpp v29, v35, v13 quad_perm:[0,0,0,0] row_mask:0xf bank_mask:0xf
    v_mfma_f32_16x16x16_bf16 v[24:27], v[30:31], v[118:119], v[24:27]
    v_and_b32_dpp v30, v35, v12 quad_perm:[1,1,1,1] row_mask:0xf bank_mask:0xf
    v_and_b32_dpp v31, v35, v13 quad_perm:[1,1,1,1] row_mask:0xf bank_mask:0xf
    s_waitcnt vmcnt(26)
    v_mfma_f32_16x16x16_bf16 v[20:23], v[28:29], v[120:121], v[20:23]
    v_and_b32_dpp v28, v35, v12 quad_perm:[2,2,2,2] row_mask:0xf bank_mask:0xf
    v_and_b32_dpp v29, v35, v13 quad_perm:[2,2,2,2] row_mask:0xf bank_mask:0xf
    v_mfma_f32_16x16x16_bf16 v[24:27], v[30:31], v[122:123], v[24:27]
    v_and_b32_dpp v30, v35, v12 quad_perm:[3,3,3,3] row_mask:0xf bank_mask:0xf
    v_and_b32_dpp v31, v35, v13 quad_perm:[3,3,3,3] row_mask:0xf bank_mask:0xf
    s_waitcnt vmcnt(24)
    v_mfma_f32_16x16x16_bf16 v[20:23], v[28:29], v[124:125], v[20:23]
    v_and_b32_dpp v28, v36, v12 quad_perm:[0,0,0,0] row_mask:0xf bank_mask:0xf
    v_and_b32_dpp v29, v36, v13 quad_perm:[0,0,0,0] row_mask:0xf bank_mask:0xf
    v_mfma_f32_16x16x16_bf16 v[24:27], v[30:31], v[126:127], v[24:27]
    v_and_b32_dpp v30, v36, v12 quad_perm:[1,1,1,1] row_mask:0xf bank_mask:0xf
    v_and_b32_dpp v31, v36, v13 quad_perm:[1,1,1,1] row_mask:0xf bank_mask:0xf
    s_waitcnt vmcnt(22)
    v_mfma_f32_16x16x16_bf16 v[20:23], v[28:29], v[128:129], v[20:23]
    v_and_b32_dpp v28, v36, v12 quad_perm:[2,2,2,2] row_mask:0xf bank_mask:0xf
    v_and_b32_dpp v29, v36, v13 quad_perm:[2,2,2,2] row_mask:0xf bank_mask:0xf
    v_mfma_f32_16x16x16_bf16 v[24:27], v[30:31], v[130:131], v[24:27]
    v_and_b32_dpp v30, v36, v12 quad_perm:[3,3,3,3] row_mask:0xf bank_mask:0xf
    v_and_b32_dpp v31, v36, v13 quad_perm:[3,3,3,3] row_mask:0xf bank_mask:0xf
    s_waitcnt vmcnt(20)
    v_mfma_f32_16x16x16_bf16 v[20:23], v[28:29], v[132:133], v[20:23]
    v_and_b32_dpp v28, v37, v12 quad_perm:[0,0,0,0] row_mask:0xf bank_mask:0xf
    v_and_b32_dpp v29, v37, v13 quad_perm:[0,0,0,0] row_mask:0xf bank_mask:0xf
    v_mfma_f32_16x16x16_bf16 v[24:27], v[30:31], v[134:135], v[24:27]
    v_and_b32_dpp v30, v37, v12 quad_perm:[1,1,1,1] row_mask:0xf bank_mask:0xf
    v_and_b32_dpp v31, v37, v13 quad_perm:[1,1,1,1] row_mask:0xf bank_mask:0xf
    s_waitcnt vmcnt(18)
    v_mfma_f32_16x16x16_bf16 v[20:23], v[28:29], v[136:137], v[20:23]
    v_and_b32_dpp v28, v37, v12 quad_perm:[2,2,2,2] row_mask:0xf bank_mask:0xf
    v_and_b32_dpp v29, v37, v13 quad_perm:[2,2,2,2] row_mask:0xf bank_mask:0xf
    v_mfma_f32_16x16x16_bf16 v[24:27], v[30:31], v[138:139], v[24:27]
    v_and_b32_dpp v30, v37, v12 quad_perm:[3,3,3,3] row_mask:0xf bank_mask:0xf
    v_and_b32_dpp v31, v37, v13 quad_perm:[3,3,3,3] row_mask:0xf bank_mask:0xf
    s_waitcnt vmcnt(16)
    v_mfma_f32_16x16x16_bf16 v[20:23], v[28:29], v[140:141], v[20:23]
    v_and_b32_dpp v28, v38, v12 quad_perm:[0,0,0,0] row_mask:0xf bank_mask:0xf
    v_and_b32_dpp v29, v38, v13 quad_perm:[0,0,0,0] row_mask:0xf bank_mask:0xf
    v_mfma_f32_16x16x16_bf16 v[24:27], v[30:31], v[142:143], v[24:27]
    v_and_b32_dpp v30, v38, v12 quad_perm:[1,1,1,1] row_mask:0xf bank_mask:0xf
    v_and_b32_dpp v31, v38, v13 quad_perm:[1,1,1,1] row_mask:0xf bank_mask:0xf
    s_waitcnt vmcnt(14)
    v_mfma_f32_16x16x16_bf16 v[20:23], v[28:29], v[144:145], v[20:23]
    v_and_b32_dpp v28, v38, v12 quad_perm:[2,2,2,2] row_mask:0xf bank_mask:0xf
    v_and_b32_dpp v29, v38, v13 quad_perm:[2,2,2,2] row_mask:0xf bank_mask:0xf
    v_mfma_f32_16x16x16_bf16 v[24:27], v[30:31], v[146:147], v[24:27]
    v_and_b32_dpp v30, v38, v12 quad_perm:[3,3,3,3] row_mask:0xf bank_mask:0xf
    v_and_b32_dpp v31, v38, v13 quad_perm:[3,3,3,3] row_mask:0xf bank_mask:0xf
    s_waitcnt vmcnt(12)
    v_mfma_f32_16x16x16_bf16 v[20:23], v[28:29], v[148:149], v[20:23]
    v_and_b32_dpp v28, v39, v12 quad_perm:[0,0,0,0] row_mask:0xf bank_mask:0xf
    v_and_b32_dpp v29, v39, v13 quad_perm:[0,0,0,0] row_mask:0xf bank_mask:0xf
    v_mfma_f32_16x16x16_bf16 v[24:27], v[30:31], v[150:151], v[24:27]
    v_and_b32_dpp v30, v39, v12 quad_perm:[1,1,1,1] row_mask:0xf bank_mask:0xf
    v_and_b32_dpp v31, v39, v13 quad_perm:[1,1,1,1] row_mask:0xf bank_mask:0xf
    s_waitcnt vmcnt(10)
    v_mfma_f32_16x16x16_bf16 v[20:23], v[28:29], v[152:153], v[20:23]
    v_and_b32_dpp v28, v39, v12 quad_perm:[2,2,2,2] row_mask:0xf bank_mask:0xf
    v_and_b32_dpp v29, v39, v13 quad_perm:[2,2,2,2] row_mask:0xf bank_mask:0xf
    v_mfma_f32_16x16x16_bf16 v[24:27], v[30:31], v[154:155], v[24:27]
    v_and_b32_dpp v30, v39, v12 quad_perm:[3,3,3,3] row_mask:0xf bank_mask:0xf
    v_and_b32_dpp v31, v39, v13 quad_perm:[3,3,3,3] row_mask:0xf bank_mask:0xf
    s_waitcnt vmcnt(8)
    v_mfma_f32_16x16x16_bf16 v[20:23], v[28:29], v[156:157], v[20:23]
    v_and_b32_dpp v28, v40, v12 quad_perm:[0,0,0,0] row_mask:0xf bank_mask:0xf
    v_and_b32_dpp v29, v40, v13 quad_perm:[0,0,0,0] row_mask:0xf bank_mask:0xf
    v_mfma_f32_16x16x16_bf16 v[24:27], v[30:31], v[158:159], v[24:27]
    v_and_b32_dpp v30, v40, v12 quad_perm:[1,1,1,1] row_mask:0xf bank_mask:0xf
    v_and_b32_dpp v31, v40, v13 quad_perm:[1,1,1,1] row_mask:0xf bank_mask:0xf
    s_waitcnt vmcnt(6)
    v_mfma_f32_16x16x16_bf16 v[20:23], v[28:29], v[160:161], v[20:23]
    v_and_b32_dpp v28, v40, v12 quad_perm:[2,2,2,2] row_mask:0xf bank_mask:0xf
    v_and_b32_dpp v29, v40, v13 quad_perm:[2,2,2,2] row_mask:0xf bank_mask:0xf
    v_mfma_f32_16x16x16_bf16 v[24:27], v[30:31], v[162:163], v[24:27]
    v_and_b32_dpp v30, v40, v12 quad_perm:[3,3,3,3] row_mask:0xf bank_mask:0xf
    v_and_b32_dpp v31, v40, v13 quad_perm:[3,3,3,3] row_mask:0xf bank_mask:0xf
    s_waitcnt vmcnt(4)
    v_mfma_f32_16x16x16_bf16 v[20:23], v[28:29], v[164:165], v[20:23]
    v_and_b32_dpp v28, v41, v12 quad_perm:[0,0,0,0] row_mask:0xf bank_mask:0xf
    v_and_b32_dpp v29, v41, v13 quad_perm:[0,0,0,0] row_mask:0xf bank_mask:0xf
    v_mfma_f32_16x16x16_bf16 v[24:27], v[30:31], v[166:167], v[24:27]
    v_and_b32_dpp v30, v41, v12 quad_perm:[1,1,1,1] row_mask:0xf bank_mask:0xf
    v_and_b32_dpp v31, v41, v13 quad_perm:[1,1,1,1] row_mask:0xf bank_mask:0xf
    s_waitcnt vmcnt(2)
    v_mfma_f32_16x16x16_bf16 v[20:23], v[28:29], v[168:169], v[20:23]
    v_and_b32_dpp v28, v41, v12 quad_perm:[2,2,2,2] row_mask:0xf bank_mask:0xf
    v_and_b32_dpp v29, v41, v13 quad_perm:[2,2,2,2] row_mask:0xf bank_mask:0xf
    v_mfma_f32_16x16x16_bf16 v[24:27], v[30:31], v[170:171], v[24:27]
    v_and_b32_dpp v30, v41, v12 quad_perm:[3,3,3,3] row_mask:0xf bank_mask:0xf
    v_and_b32_dpp v31, v41, v13 quad_perm:[3,3,3,3] row_mask:0xf bank_mask:0xf
    s_waitcnt vmcnt(0)
    v_mfma_f32_16x16x16_bf16 v[20:23], v[28:29], v[172:173], v[20:23]
    s_nop 1
    v_mfma_f32_16x16x16_bf16 v[24:27], v[30:31], v[174:175], v[24:27]
L_common:
    s_mov_b32 s56, s20
    s_and_b32 s57, s21, 0xffff
    s_mov_b32 s58, 2211840
    s_mov_b32 s59, 0x20000
    s_mov_b32 s60, s12
    s_and_b32 s61, s13, 0xffff
    s_mov_b32 s62, 5242880
    s_mov_b32 s63, 0x20000
    s_mov_b32 s68, s22
    s_and_b32 s69, s23, 0xffff
    s_mov_b32 s70, 5120
    s_mov_b32 s71, 0x20000
    v_mul_u32_u24 v1, 1280, v3
    v_lshl_add_u32 v1, v2, 4, v1
    v_mov_b32 v32, 0
    v_mov_b32 v33, 0
    v_mov_b32 v34, 0
    v_mov_b32 v35, 0
    v_mov_b32 v36, 0
    v_mov_b32 v37, 0
    v_mov_b32 v38, 0
    v_mov_b32 v39, 0
    v_mov_b32 v40, 0
    v_mov_b32 v41, 0
    v_mov_b32 v42, 0
    v_mov_b32 v43, 0
    v_mov_b32 v44, 0
    v_mov_b32 v45, 0
    v_mov_b32 v46, 0
    v_mov_b32 v47, 0
    v_mov_b32 v48, 0
    v_mov_b32 v49, 0
    v_mov_b32 v50, 0
    v_mov_b32 v51, 0
    s_mul_i32 s35, s28, 1280
    s_min_u32 s36, s31, 19
    s_lshl_b32 s36, s36, 6
    s_add_u32 s35, s35, s36
    v_and_b32 v10, 7, v0
    v_lshlrev_b32 v10, 3, v10
    buffer_load_dwordx2 v[60:61], v10, s[40:43], s35 offen
    s_cmp_eq_u32 s34, 1
    s_cbranch_scc1 L_k1
    s_lshl_b32 s35, s29, 7
    s_lshl_b32 s36, s34, 5
    s_add_u32 s35, s35, s36
    s_mul_i32 s35, s35, 1280
    buffer_load_dwordx4 v[96:99], v1, s[60:63], s35 offen offset:0
    buffer_load_dwordx4 v[100:103], v1, s[60:63], s35 offen offset:256
    buffer_load_dwordx4 v[104:107], v1, s[60:63], s35 offen offset:512
    buffer_load_dwordx4 v[108:111], v1, s[60:63], s35 offen offset:768
    s_waitcnt vmcnt(3)
    buffer_load_dwordx4 v[112:115], v1, s[60:63], s35 offen offset:1024
    s_add_u32 s35, s35, 5120
    s_waitcnt vmcnt(3)
    buffer_load_dwordx4 v[116:119], v1, s[60:63], s35 offen offset:0
    s_waitcnt vmcnt(3)
    buffer_load_dwordx4 v[120:123], v1, s[60:63], s35 offen offset:256
    s_waitcnt vmcnt(3)
    buffer_load_dwordx4 v[124:127], v1, s[60:63], s35 offen offset:512
    s_waitcnt vmcnt(3)
    buffer_load_dwordx4 v[128:131], v1, s[60:63], s35 offen offset:768
    s_waitcnt vmcnt(3)
    buffer_load_dwordx4 v[132:135], v1, s[60:63], s35 offen offset:1024
    s_add_u32 s35, s35, 5120
    s_waitcnt vmcnt(3)
    buffer_load_dwordx4 v[136:139], v1, s[60:63], s35 offen offset:0
    s_waitcnt vmcnt(3)
    buffer_load_dwordx4 v[140:143], v1, s[60:63], s35 offen offset:256
    s_waitcnt vmcnt(3)
    buffer_load_dwordx4 v[144:147], v1, s[60:63], s35 offen offset:512
    s_waitcnt vmcnt(3)
    buffer_load_dwordx4 v[148:151], v1, s[60:63], s35 offen offset:768
    s_waitcnt vmcnt(3)
    buffer_load_dwordx4 v[152:155], v1, s[60:63], s35 offen offset:1024
    s_add_u32 s35, s35, 5120
    s_waitcnt vmcnt(3)
    buffer_load_dwordx4 v[156:159], v1, s[60:63], s35 offen offset:0
    s_waitcnt vmcnt(3)
    buffer_load_dwordx4 v[160:163], v1, s[60:63], s35 offen offset:256
    s_waitcnt vmcnt(3)
    buffer_load_dwordx4 v[164:167], v1, s[60:63], s35 offen offset:512
    s_waitcnt vmcnt(3)
    buffer_load_dwordx4 v[168:171], v1, s[60:63], s35 offen offset:768
    s_waitcnt vmcnt(3)
    buffer_load_dwordx4 v[172:175], v1, s[60:63], s35 offen offset:1024
    s_add_u32 s35, s35, 5120
    s_waitcnt vmcnt(3)
    buffer_load_dwordx4 v[176:179], v1, s[60:63], s35 offen offset:0
    s_waitcnt vmcnt(3)
    buffer_load_dwordx4 v[180:183], v1, s[60:63], s35 offen offset:256
    s_waitcnt vmcnt(3)
    buffer_load_dwordx4 v[184:187], v1, s[60:63], s35 offen offset:512
    s_waitcnt vmcnt(3)
    buffer_load_dwordx4 v[188:191], v1, s[60:63], s35 offen offset:768
    s_waitcnt vmcnt(3)
    buffer_load_dwordx4 v[192:195], v1, s[60:63], s35 offen offset:1024
    s_add_u32 s35, s35, 5120
    s_waitcnt vmcnt(3)
    buffer_load_dwordx4 v[196:199], v1, s[60:63], s35 offen offset:0
    s_waitcnt vmcnt(3)
    buffer_load_dwordx4 v[200:203], v1, s[60:63], s35 offen offset:256
    s_waitcnt vmcnt(3)
    buffer_load_dwordx4 v[204:207], v1, s[60:63], s35 offen offset:512
    s_waitcnt vmcnt(3)
    buffer_load_dwordx4 v[208:211], v1, s[60:63], s35 offen offset:768
    s_waitcnt vmcnt(3)
    buffer_load_dwordx4 v[212:215], v1, s[60:63], s35 offen offset:1024
    s_add_u32 s35, s35, 5120
    s_waitcnt vmcnt(3)
    buffer_load_dwordx4 v[216:219], v1, s[60:63], s35 offen offset:0
    s_waitcnt vmcnt(3)
    buffer_load_dwordx4 v[220:223], v1, s[60:63], s35 offen offset:256
    s_waitcnt vmcnt(3)
    buffer_load_dwordx4 v[224:227], v1, s[60:63], s35 offen offset:512
    s_waitcnt vmcnt(3)
    buffer_load_dwordx4 v[228:231], v1, s[60:63], s35 offen offset:768
    s_waitcnt vmcnt(3)
    buffer_load_dwordx4 v[232:235], v1, s[60:63], s35 offen offset:1024
    s_add_u32 s35, s35, 5120
    s_waitcnt vmcnt(3)
    buffer_load_dwordx4 v[236:239], v1, s[60:63], s35 offen offset:0
    s_waitcnt vmcnt(3)
    buffer_load_dwordx4 v[240:243], v1, s[60:63], s35 offen offset:256
    s_waitcnt vmcnt(3)
    buffer_load_dwordx4 v[244:247], v1, s[60:63], s35 offen offset:512
    s_waitcnt vmcnt(3)
    buffer_load_dwordx4 v[248:251], v1, s[60:63], s35 offen offset:768
    s_waitcnt vmcnt(3)
    buffer_load_dwordx4 v[252:255], v1, s[60:63], s35 offen offset:1024
    s_branch L_kdone
L_k1:
L_kdone:
    s_barrier
    s_cmp_eq_u32 s34, 1
    s_cbranch_scc1 L_v1
    s_cmp_eq_u32 s34, 0
    s_cbranch_scc0 L_nostat
    v_mov_b32 v8, 0
    ds_read_b128 v[80:83], v8 offset:2048
    ds_read_b128 v[84:87], v8 offset:2064
    s_mov_b32 s73, 0x3fb8aa3b
    s_waitcnt lgkmcnt(0)
    v_max3_f32 v88, v80, v82, v84
    v_max_f32 v88, v88, v86
    v_sub_f32 v64, v80, v88
    v_sub_f32 v65, v82, v88
    v_sub_f32 v66, v84, v88
    v_sub_f32 v67, v86, v88
    v_mul_f32 v64, s73, v64
    v_mul_f32 v65, s73, v65
    v_mul_f32 v66, s73, v66
    v_mul_f32 v67, s73, v67
    v_exp_f32 v64, v64
    v_exp_f32 v65, v65
    v_exp_f32 v66, v66
    v_exp_f32 v67, v67
    s_nop 0
    v_mul_f32 v90, v64, v81
    v_fma_f32 v90, v65, v83, v90
    v_fma_f32 v90, v66, v85, v90
    v_fma_f32 v90, v67, v87, v90
    v_mov_b32 v89, s72
    v_mov_b32 v91, s72
    s_lshl_b32 s35, s30, 7
    s_add_u32 s35, s35, 4096
    s_mov_b64 exec, 1
    buffer_store_dwordx4 v[88:91], off, s[64:67], s35 sc1 nt
    s_mov_b64 exec, -1
L_nostat:
    s_cmp_lg_u32 s34, 2
    s_cbranch_scc1 L_nofpub
    s_mov_b32 s99, s2
    s_cmp_ge_u32 s99, 216
    s_cbranch_scc1 L_nofpub
    s_lshl_b32 s81, s99, 10
    s_add_u32 s81, s81, 2490368
    v_lshlrev_b32 v11, 4, v0
    v_mov_b32 v72, s72
    v_add_f32 v64, v20, v24
    v_add_f32 v65, v21, v25
    v_add_f32 v66, v22, v26
    v_add_f32 v67, v23, v27
    v_add_u32 v68, 0x80, v64
    v_add_u32 v69, 0x80, v65
    v_add_u32 v70, 0x80, v66
    v_add_u32 v71, 0x80, v67
    v_perm_b32 v68, v68, v72, s92
    v_perm_b32 v69, v69, v72, s93
    v_perm_b32 v70, v70, v72, s94
    v_perm_b32 v71, v71, v72, s95
    buffer_store_dwordx4 v[68:71], v11, s[64:67], s81 offen sc1 nt
L_nofpub:
    s_branch L_vdone
L_v1:
    s_mul_i32 s37, s31, 28
    s_mul_i32 s36, s31, 24
    s_add_u32 s36, s36, 192
    s_cmp_lt_u32 s31, 48
    s_cselect_b32 s37, s37, s36
    s_mul_i32 s35, s37, 1280
    buffer_load_dwordx4 v[96:99], v1, s[56:59], s35 offen offset:0 nt
    buffer_load_dwordx4 v[100:103], v1, s[56:59], s35 offen offset:256 nt
    buffer_load_dwordx4 v[104:107], v1, s[56:59], s35 offen offset:512 nt
    buffer_load_dwordx4 v[108:111], v1, s[56:59], s35 offen offset:768 nt
    s_waitcnt vmcnt(3)
    buffer_load_dwordx4 v[112:115], v1, s[56:59], s35 offen offset:1024 nt
    s_add_u32 s35, s35, 5120
    s_waitcnt vmcnt(3)
    buffer_load_dwordx4 v[116:119], v1, s[56:59], s35 offen offset:0 nt
    s_waitcnt vmcnt(3)
    buffer_load_dwordx4 v[120:123], v1, s[56:59], s35 offen offset:256 nt
    s_waitcnt vmcnt(3)
    buffer_load_dwordx4 v[124:127], v1, s[56:59], s35 offen offset:512 nt
    s_waitcnt vmcnt(3)
    buffer_load_dwordx4 v[128:131], v1, s[56:59], s35 offen offset:768 nt
    s_waitcnt vmcnt(3)
    buffer_load_dwordx4 v[132:135], v1, s[56:59], s35 offen offset:1024 nt
    s_add_u32 s35, s35, 5120
    s_waitcnt vmcnt(3)
    buffer_load_dwordx4 v[136:139], v1, s[56:59], s35 offen offset:0 nt
    s_waitcnt vmcnt(3)
    buffer_load_dwordx4 v[140:143], v1, s[56:59], s35 offen offset:256 nt
    s_waitcnt vmcnt(3)
    buffer_load_dwordx4 v[144:147], v1, s[56:59], s35 offen offset:512 nt
    s_waitcnt vmcnt(3)
    buffer_load_dwordx4 v[148:151], v1, s[56:59], s35 offen offset:768 nt
    s_waitcnt vmcnt(3)
    buffer_load_dwordx4 v[152:155], v1, s[56:59], s35 offen offset:1024 nt
    s_add_u32 s35, s35, 5120
    s_waitcnt vmcnt(3)
    buffer_load_dwordx4 v[156:159], v1, s[56:59], s35 offen offset:0 nt
    s_waitcnt vmcnt(3)
    buffer_load_dwordx4 v[160:163], v1, s[56:59], s35 offen offset:256 nt
    s_waitcnt vmcnt(3)
    buffer_load_dwordx4 v[164:167], v1, s[56:59], s35 offen offset:512 nt
    s_waitcnt vmcnt(3)
    buffer_load_dwordx4 v[168:171], v1, s[56:59], s35 offen offset:768 nt
    s_waitcnt vmcnt(3)
    buffer_load_dwordx4 v[172:175], v1, s[56:59], s35 offen offset:1024 nt
    s_add_u32 s35, s35, 5120
    s_waitcnt vmcnt(3)
    buffer_load_dwordx4 v[176:179], v1, s[56:59], s35 offen offset:0 nt
    s_waitcnt vmcnt(3)
    buffer_load_dwordx4 v[180:183], v1, s[56:59], s35 offen offset:256 nt
    s_waitcnt vmcnt(3)
    buffer_load_dwordx4 v[184:187], v1, s[56:59], s35 offen offset:512 nt
    s_waitcnt vmcnt(3)
    buffer_load_dwordx4 v[188:191], v1, s[56:59], s35 offen offset:768 nt
    s_waitcnt vmcnt(3)
    buffer_load_dwordx4 v[192:195], v1, s[56:59], s35 offen offset:1024 nt
    s_add_u32 s35, s35, 5120
    s_waitcnt vmcnt(3)
    buffer_load_dwordx4 v[196:199], v1, s[56:59], s35 offen offset:0 nt
    s_waitcnt vmcnt(3)
    buffer_load_dwordx4 v[200:203], v1, s[56:59], s35 offen offset:256 nt
    s_waitcnt vmcnt(3)
    buffer_load_dwordx4 v[204:207], v1, s[56:59], s35 offen offset:512 nt
    s_waitcnt vmcnt(3)
    buffer_load_dwordx4 v[208:211], v1, s[56:59], s35 offen offset:768 nt
    s_waitcnt vmcnt(3)
    buffer_load_dwordx4 v[212:215], v1, s[56:59], s35 offen offset:1024 nt
    s_add_u32 s35, s35, 5120
    s_sub_u32 s36, s35, 5120
    s_cmp_lt_u32 s31, 48
    s_cselect_b32 s35, s35, s36
    s_waitcnt vmcnt(3)
    buffer_load_dwordx4 v[216:219], v1, s[56:59], s35 offen offset:0 nt
    s_waitcnt vmcnt(3)
    buffer_load_dwordx4 v[220:223], v1, s[56:59], s35 offen offset:256 nt
    s_waitcnt vmcnt(3)
    buffer_load_dwordx4 v[224:227], v1, s[56:59], s35 offen offset:512 nt
    s_waitcnt vmcnt(3)
    buffer_load_dwordx4 v[228:231], v1, s[56:59], s35 offen offset:768 nt
    s_waitcnt vmcnt(3)
    buffer_load_dwordx4 v[232:235], v1, s[56:59], s35 offen offset:1024 nt
    v_mov_b32 v8, 0
    ds_read_b128 v[80:83], v8 offset:2048
    ds_read_b128 v[84:87], v8 offset:2064
    s_mov_b32 s73, 0x3fb8aa3b
    s_waitcnt lgkmcnt(0)
    v_max3_f32 v88, v80, v82, v84
    v_max_f32 v88, v88, v86
    v_sub_f32 v240, v80, v88
    v_sub_f32 v241, v82, v88
    v_sub_f32 v242, v84, v88
    v_sub_f32 v243, v86, v88
    v_mul_f32 v240, s73, v240
    v_mul_f32 v241, s73, v241
    v_mul_f32 v242, s73, v242
    v_mul_f32 v243, s73, v243
    v_exp_f32 v240, v240
    v_exp_f32 v241, v241
    v_exp_f32 v242, v242
    v_exp_f32 v243, v243
    s_nop 0
    v_mul_f32 v90, v240, v81
    v_fma_f32 v90, v241, v83, v90
    v_fma_f32 v90, v242, v85, v90
    v_fma_f32 v90, v243, v87, v90
    s_mul_i32 s37, s31, 28
    s_mul_i32 s36, s31, 24
    s_add_u32 s36, s36, 192
    s_cmp_lt_u32 s31, 48
    s_cselect_b32 s37, s37, s36
    v_and_b32 v8, 7, v2
    s_cmp_lt_u32 s31, 48
    s_cselect_b32 s36, 6, 5
    v_min_u32 v8, s36, v8
    v_lshlrev_b32 v8, 2, v8
    v_add_u32 v8, s37, v8
    v_lshrrev_b32 v9, 6, v8
    v_lshrrev_b32 v10, 3, v2
    v_mul_u32_u24 v10, 27, v10
    v_add_u32 v9, v9, v10
    v_lshl_add_u32 v9, v9, 2, v3
    v_lshlrev_b32 v9, 10, v9
    v_bfe_u32 v10, v8, 2, 4
    v_lshl_add_u32 v9, v10, 4, v9
    s_lshl_b32 s82, s28, 8
    s_add_u32 s82, s82, 2490368
    s_lshl_b32 s83, s30, 7
    s_add_u32 s83, s83, 4096
    s_xor_b32 s83, s83, 128
    s_mov_b32 s36, 20000
L_pollg:
    buffer_load_dwordx4 v[236:239], off, s[64:67], s83 sc1 nt
    s_add_u32 s35, s82, 229376
    buffer_load_dwordx4 v[64:67], v9, s[64:67], s82 offen sc1 nt
    s_waitcnt vmcnt(0)
    v_perm_b32 v72, v65, v64, s96
    v_perm_b32 v72, v66, v72, s97
    v_perm_b32 v72, v67, v72, s98
    v_min3_u32 v8, v237, v239, v72
    v_max3_u32 v10, v237, v239, v72
    v_cmp_ne_u32 vcc, s72, v8
    v_cmp_ne_u32_e64 s[74:75], s72, v10
    s_nop 1
    s_or_b64 s[74:75], vcc, s[74:75]
    s_cbranch_scc0 L_pollg_done
    s_sub_u32 s36, s36, 1
    s_cmp_lg_u32 s36, 0
    s_cbranch_scc1 L_pollg
L_pollg_done:
    v_max_f32 v80, v88, v236
    v_sub_f32 v81, v88, v80
    v_sub_f32 v82, v236, v80
    v_mul_f32 v81, s73, v81
    v_mul_f32 v82, s73, v82
    v_exp_f32 v81, v81
    v_exp_f32 v82, v82
    s_nop 0
    v_mul_f32 v83, v81, v90
    v_fma_f32 v83, v82, v238, v83
    v_rcp_f32 v82, v83
    s_nop 0
    v_fma_f32 v80, -v83, v82, 1.0
    v_fma_f32 v82, v80, v82, v82
    v_mul_f32 v81, v81, v82
    v_mul_f32 v240, v240, v81
    v_mul_f32 v241, v241, v81
    v_mul_f32 v242, v242, v81
    v_mul_f32 v243, v243, v81
    v_mov_b32 v8, 384
    ds_write_b128 v8, v[240:243]
    v_and_b32 v64, 0xffffff00, v64
    v_and_b32 v65, 0xffffff00, v65
    v_and_b32 v66, 0xffffff00, v66
    v_and_b32 v67, 0xffffff00, v67
    v_mov_b32 v72, v64
    v_mov_b32 v73, v65
    v_mov_b32 v74, v66
    v_mov_b32 v75, v67
    s_nop 1
    v_permlane16_swap_b32 v64, v72
    v_permlane16_swap_b32 v65, v73
    v_permlane16_swap_b32 v66, v74
    v_permlane16_swap_b32 v67, v75
    s_nop 0
    v_add_f32 v64, v64, v72
    v_add_f32 v65, v65, v73
    v_add_f32 v66, v66, v74
    v_add_f32 v67, v67, v75
    v_mov_b32 v72, v64
    v_mov_b32 v73, v65
    v_mov_b32 v74, v66
    v_mov_b32 v75, v67
    s_nop 1
    v_permlane32_swap_b32 v64, v72
    v_permlane32_swap_b32 v65, v73
    v_permlane32_swap_b32 v66, v74
    v_permlane32_swap_b32 v67, v75
    s_nop 0
    v_add_f32 v64, v64, v72
    v_add_f32 v65, v65, v73
    v_add_f32 v66, v66, v74
    v_add_f32 v67, v67, v75
    s_mov_b32 s74, 0xffff0000
    s_mov_b32 s75, 0xffff0000
    s_mov_b32 s76, 0
    s_mov_b32 s77, -1
    v_cndmask_b32_e64 v64, v64, v65, s[74:75]
    v_cndmask_b32_e64 v66, v66, v67, s[74:75]
    v_cndmask_b32_e64 v64, v64, v66, s[76:77]
    v_cvt_pk_bf16_f32 v64, v64, v64
    v_lshlrev_b32 v64, 16, v64
    v_cmp_ne_u32 vcc, 6, v2
    s_cmp_lt_u32 s31, 48
    s_cselect_b64 s[74:75], -1, 0
    v_mov_b32_dpp v65, v64 row_ror:8 row_mask:0xf bank_mask:0xf
    v_max_f32 v64, 0, v64
    s_or_b64 vcc, vcc, s[74:75]
    v_mul_f32 v64, v64, v65
    v_cvt_pk_bf16_f32 v64, v64, v64
    v_cndmask_b32 v64, 0, v64, vcc
    s_nop 1
    v_and_b32_dpp v52, v64, v4 row_newbcast:0 row_mask:0xf bank_mask:0xf
    v_and_b32_dpp v53, v64, v5 row_newbcast:0 row_mask:0xf bank_mask:0xf
    v_and_b32_dpp v54, v64, v6 row_newbcast:0 row_mask:0xf bank_mask:0xf
    v_and_b32_dpp v55, v64, v7 row_newbcast:0 row_mask:0xf bank_mask:0xf
    v_and_b32_dpp v56, v64, v4 row_newbcast:1 row_mask:0xf bank_mask:0xf
    v_and_b32_dpp v57, v64, v5 row_newbcast:1 row_mask:0xf bank_mask:0xf
    v_and_b32_dpp v58, v64, v6 row_newbcast:1 row_mask:0xf bank_mask:0xf
    v_and_b32_dpp v59, v64, v7 row_newbcast:1 row_mask:0xf bank_mask:0xf
    v_mfma_f32_16x16x32_bf16 v[32:35], v[52:55], v[96:99], v[32:35]
    v_mfma_f32_16x16x32_bf16 v[36:39], v[52:55], v[100:103], v[36:39]
    v_mfma_f32_16x16x32_bf16 v[40:43], v[52:55], v[104:107], v[40:43]
    v_mfma_f32_16x16x32_bf16 v[44:47], v[52:55], v[108:111], v[44:47]
    v_mfma_f32_16x16x32_bf16 v[48:51], v[52:55], v[112:115], v[48:51]
    v_and_b32_dpp v52, v64, v4 row_newbcast:2 row_mask:0xf bank_mask:0xf
    v_and_b32_dpp v53, v64, v5 row_newbcast:2 row_mask:0xf bank_mask:0xf
    v_and_b32_dpp v54, v64, v6 row_newbcast:2 row_mask:0xf bank_mask:0xf
    v_and_b32_dpp v55, v64, v7 row_newbcast:2 row_mask:0xf bank_mask:0xf
    v_mfma_f32_16x16x32_bf16 v[32:35], v[56:59], v[116:119], v[32:35]
    v_mfma_f32_16x16x32_bf16 v[36:39], v[56:59], v[120:123], v[36:39]
    v_mfma_f32_16x16x32_bf16 v[40:43], v[56:59], v[124:127], v[40:43]
    v_mfma_f32_16x16x32_bf16 v[44:47], v[56:59], v[128:131], v[44:47]
    v_mfma_f32_16x16x32_bf16 v[48:51], v[56:59], v[132:135], v[48:51]
    v_and_b32_dpp v56, v64, v4 row_newbcast:3 row_mask:0xf bank_mask:0xf
    v_and_b32_dpp v57, v64, v5 row_newbcast:3 row_mask:0xf bank_mask:0xf
    v_and_b32_dpp v58, v64, v6 row_newbcast:3 row_mask:0xf bank_mask:0xf
    v_and_b32_dpp v59, v64, v7 row_newbcast:3 row_mask:0xf bank_mask:0xf
    v_mfma_f32_16x16x32_bf16 v[32:35], v[52:55], v[136:139], v[32:35]
    v_mfma_f32_16x16x32_bf16 v[36:39], v[52:55], v[140:143], v[36:39]
    v_mfma_f32_16x16x32_bf16 v[40:43], v[52:55], v[144:147], v[40:43]
    v_mfma_f32_16x16x32_bf16 v[44:47], v[52:55], v[148:151], v[44:47]
    v_mfma_f32_16x16x32_bf16 v[48:51], v[52:55], v[152:155], v[48:51]
    v_and_b32_dpp v52, v64, v4 row_newbcast:4 row_mask:0xf bank_mask:0xf
    v_and_b32_dpp v53, v64, v5 row_newbcast:4 row_mask:0xf bank_mask:0xf
    v_and_b32_dpp v54, v64, v6 row_newbcast:4 row_mask:0xf bank_mask:0xf
    v_and_b32_dpp v55, v64, v7 row_newbcast:4 row_mask:0xf bank_mask:0xf
    v_mfma_f32_16x16x32_bf16 v[32:35], v[56:59], v[156:159], v[32:35]
    v_mfma_f32_16x16x32_bf16 v[36:39], v[56:59], v[160:163], v[36:39]
    v_mfma_f32_16x16x32_bf16 v[40:43], v[56:59], v[164:167], v[40:43]
    v_mfma_f32_16x16x32_bf16 v[44:47], v[56:59], v[168:171], v[44:47]
    v_mfma_f32_16x16x32_bf16 v[48:51], v[56:59], v[172:175], v[48:51]
    v_and_b32_dpp v56, v64, v4 row_newbcast:5 row_mask:0xf bank_mask:0xf
    v_and_b32_dpp v57, v64, v5 row_newbcast:5 row_mask:0xf bank_mask:0xf
    v_and_b32_dpp v58, v64, v6 row_newbcast:5 row_mask:0xf bank_mask:0xf
    v_and_b32_dpp v59, v64, v7 row_newbcast:5 row_mask:0xf bank_mask:0xf
    v_mfma_f32_16x16x32_bf16 v[32:35], v[52:55], v[176:179], v[32:35]
    v_mfma_f32_16x16x32_bf16 v[36:39], v[52:55], v[180:183], v[36:39]
    v_mfma_f32_16x16x32_bf16 v[40:43], v[52:55], v[184:187], v[40:43]
    v_mfma_f32_16x16x32_bf16 v[44:47], v[52:55], v[188:191], v[44:47]
    v_mfma_f32_16x16x32_bf16 v[48:51], v[52:55], v[192:195], v[48:51]
    v_and_b32_dpp v52, v64, v4 row_newbcast:6 row_mask:0xf bank_mask:0xf
    v_and_b32_dpp v53, v64, v5 row_newbcast:6 row_mask:0xf bank_mask:0xf
    v_and_b32_dpp v54, v64, v6 row_newbcast:6 row_mask:0xf bank_mask:0xf
    v_and_b32_dpp v55, v64, v7 row_newbcast:6 row_mask:0xf bank_mask:0xf
    v_mfma_f32_16x16x32_bf16 v[32:35], v[56:59], v[196:199], v[32:35]
    v_mfma_f32_16x16x32_bf16 v[36:39], v[56:59], v[200:203], v[36:39]
    v_mfma_f32_16x16x32_bf16 v[40:43], v[56:59], v[204:207], v[40:43]
    v_mfma_f32_16x16x32_bf16 v[44:47], v[56:59], v[208:211], v[44:47]
    v_mfma_f32_16x16x32_bf16 v[48:51], v[56:59], v[212:215], v[48:51]
    s_nop 1
    v_mfma_f32_16x16x32_bf16 v[32:35], v[52:55], v[216:219], v[32:35]
    v_mfma_f32_16x16x32_bf16 v[36:39], v[52:55], v[220:223], v[36:39]
    v_mfma_f32_16x16x32_bf16 v[40:43], v[52:55], v[224:227], v[40:43]
    v_mfma_f32_16x16x32_bf16 v[44:47], v[52:55], v[228:231], v[44:47]
    v_mfma_f32_16x16x32_bf16 v[48:51], v[52:55], v[232:235], v[48:51]
    s_waitcnt lgkmcnt(0)
    s_lshl_b32 s35, s29, 7
    s_lshl_b32 s36, s34, 5
    s_add_u32 s35, s35, s36
    s_mul_i32 s35, s35, 1280
    buffer_load_dwordx4 v[96:99], v1, s[60:63], s35 offen offset:0
    buffer_load_dwordx4 v[100:103], v1, s[60:63], s35 offen offset:256
    buffer_load_dwordx4 v[104:107], v1, s[60:63], s35 offen offset:512
    buffer_load_dwordx4 v[108:111], v1, s[60:63], s35 offen offset:768
    s_waitcnt vmcnt(3)
    buffer_load_dwordx4 v[112:115], v1, s[60:63], s35 offen offset:1024
    s_add_u32 s35, s35, 5120
    s_waitcnt vmcnt(3)
    buffer_load_dwordx4 v[116:119], v1, s[60:63], s35 offen offset:0
    s_waitcnt vmcnt(3)
    buffer_load_dwordx4 v[120:123], v1, s[60:63], s35 offen offset:256
    s_waitcnt vmcnt(3)
    buffer_load_dwordx4 v[124:127], v1, s[60:63], s35 offen offset:512
    s_waitcnt vmcnt(3)
    buffer_load_dwordx4 v[128:131], v1, s[60:63], s35 offen offset:768
    s_waitcnt vmcnt(3)
    buffer_load_dwordx4 v[132:135], v1, s[60:63], s35 offen offset:1024
    s_add_u32 s35, s35, 5120
    s_waitcnt vmcnt(3)
    buffer_load_dwordx4 v[136:139], v1, s[60:63], s35 offen offset:0
    s_waitcnt vmcnt(3)
    buffer_load_dwordx4 v[140:143], v1, s[60:63], s35 offen offset:256
    s_waitcnt vmcnt(3)
    buffer_load_dwordx4 v[144:147], v1, s[60:63], s35 offen offset:512
    s_waitcnt vmcnt(3)
    buffer_load_dwordx4 v[148:151], v1, s[60:63], s35 offen offset:768
    s_waitcnt vmcnt(3)
    buffer_load_dwordx4 v[152:155], v1, s[60:63], s35 offen offset:1024
    s_add_u32 s35, s35, 5120
    s_waitcnt vmcnt(3)
    buffer_load_dwordx4 v[156:159], v1, s[60:63], s35 offen offset:0
    s_waitcnt vmcnt(3)
    buffer_load_dwordx4 v[160:163], v1, s[60:63], s35 offen offset:256
    s_waitcnt vmcnt(3)
    buffer_load_dwordx4 v[164:167], v1, s[60:63], s35 offen offset:512
    s_waitcnt vmcnt(3)
    buffer_load_dwordx4 v[168:171], v1, s[60:63], s35 offen offset:768
    s_waitcnt vmcnt(3)
    buffer_load_dwordx4 v[172:175], v1, s[60:63], s35 offen offset:1024
    s_add_u32 s35, s35, 5120
    s_waitcnt vmcnt(3)
    buffer_load_dwordx4 v[176:179], v1, s[60:63], s35 offen offset:0
    s_waitcnt vmcnt(3)
    buffer_load_dwordx4 v[180:183], v1, s[60:63], s35 offen offset:256
    s_waitcnt vmcnt(3)
    buffer_load_dwordx4 v[184:187], v1, s[60:63], s35 offen offset:512
    s_waitcnt vmcnt(3)
    buffer_load_dwordx4 v[188:191], v1, s[60:63], s35 offen offset:768
    s_waitcnt vmcnt(3)
    buffer_load_dwordx4 v[192:195], v1, s[60:63], s35 offen offset:1024
    s_add_u32 s35, s35, 5120
    s_waitcnt vmcnt(3)
    buffer_load_dwordx4 v[196:199], v1, s[60:63], s35 offen offset:0
    s_waitcnt vmcnt(3)
    buffer_load_dwordx4 v[200:203], v1, s[60:63], s35 offen offset:256
    s_waitcnt vmcnt(3)
    buffer_load_dwordx4 v[204:207], v1, s[60:63], s35 offen offset:512
    s_waitcnt vmcnt(3)
    buffer_load_dwordx4 v[208:211], v1, s[60:63], s35 offen offset:768
    s_waitcnt vmcnt(3)
    buffer_load_dwordx4 v[212:215], v1, s[60:63], s35 offen offset:1024
    s_add_u32 s35, s35, 5120
    s_waitcnt vmcnt(3)
    buffer_load_dwordx4 v[216:219], v1, s[60:63], s35 offen offset:0
    s_waitcnt vmcnt(3)
    buffer_load_dwordx4 v[220:223], v1, s[60:63], s35 offen offset:256
    s_waitcnt vmcnt(3)
    buffer_load_dwordx4 v[224:227], v1, s[60:63], s35 offen offset:512
    s_waitcnt vmcnt(3)
    buffer_load_dwordx4 v[228:231], v1, s[60:63], s35 offen offset:768
    s_waitcnt vmcnt(3)
    buffer_load_dwordx4 v[232:235], v1, s[60:63], s35 offen offset:1024
    s_add_u32 s35, s35, 5120
    s_waitcnt vmcnt(3)
    buffer_load_dwordx4 v[236:239], v1, s[60:63], s35 offen offset:0
    s_waitcnt vmcnt(3)
    buffer_load_dwordx4 v[240:243], v1, s[60:63], s35 offen offset:256
    s_waitcnt vmcnt(3)
    buffer_load_dwordx4 v[244:247], v1, s[60:63], s35 offen offset:512
    s_waitcnt vmcnt(3)
    buffer_load_dwordx4 v[248:251], v1, s[60:63], s35 offen offset:768
    s_waitcnt vmcnt(3)
    buffer_load_dwordx4 v[252:255], v1, s[60:63], s35 offen offset:1024
L_vdone:
    v_and_b32 v9, 7, v2
    v_lshl_add_u32 v9, v9, 2, v3
    s_lshl_b32 s35, s34, 5
    v_add_u32 v9, s35, v9
    v_lshlrev_b32 v9, 2, v9
    v_lshlrev_b32 v8, 5, v2
    v_lshl_add_u32 v8, v3, 4, v8
    s_mul_i32 s35, s34, 2560
    v_add_u32 v8, s35, v8
    s_mul_i32 s35, s34, 40
    v_add_u32 v10, s35, v0
    v_lshlrev_b32 v92, 4, v10
    v_lshrrev_b32 v94, 3, v10
    v_lshlrev_b32 v94, 13, v94
    v_and_b32 v10, 7, v10
    v_lshl_add_u32 v94, v10, 4, v94
    s_mul_i32 s76, s28, 163840
    s_add_u32 s76, s76, 65536
    s_lshl_b32 s77, s31, 7
    s_add_u32 s77, s77, s76
    s_waitcnt vmcnt(0)
    s_barrier
    v_mov_b32 v10, 384
    ds_read_b128 v[64:67], v10
    ds_read_b32 v80, v9 offset:2560
    ds_read_b32 v81, v9 offset:3072
    ds_read_b32 v82, v9 offset:3584
    ds_read_b32 v83, v9 offset:4096
    s_waitcnt lgkmcnt(0)
    v_mul_f32 v80, v80, v64
    v_fma_f32 v80, v81, v65, v80
    v_fma_f32 v80, v82, v66, v80
    v_fma_f32 v80, v83, v67, v80
    v_cvt_pk_bf16_f32 v80, v80, v80
    s_nop 1
    v_and_b32_dpp v52, v80, v4 row_newbcast:0 row_mask:0xf bank_mask:0xf
    v_and_b32_dpp v53, v80, v5 row_newbcast:0 row_mask:0xf bank_mask:0xf
    v_and_b32_dpp v54, v80, v6 row_newbcast:0 row_mask:0xf bank_mask:0xf
    v_and_b32_dpp v55, v80, v7 row_newbcast:0 row_mask:0xf bank_mask:0xf
    v_and_b32_dpp v56, v80, v4 row_newbcast:1 row_mask:0xf bank_mask:0xf
    v_and_b32_dpp v57, v80, v5 row_newbcast:1 row_mask:0xf bank_mask:0xf
    v_and_b32_dpp v58, v80, v6 row_newbcast:1 row_mask:0xf bank_mask:0xf
    v_and_b32_dpp v59, v80, v7 row_newbcast:1 row_mask:0xf bank_mask:0xf
    v_mfma_f32_16x16x32_bf16 v[32:35], v[52:55], v[96:99], v[32:35]
    v_mfma_f32_16x16x32_bf16 v[36:39], v[52:55], v[100:103], v[36:39]
    v_mfma_f32_16x16x32_bf16 v[40:43], v[52:55], v[104:107], v[40:43]
    v_mfma_f32_16x16x32_bf16 v[44:47], v[52:55], v[108:111], v[44:47]
    v_mfma_f32_16x16x32_bf16 v[48:51], v[52:55], v[112:115], v[48:51]
    v_and_b32_dpp v52, v80, v4 row_newbcast:2 row_mask:0xf bank_mask:0xf
    v_and_b32_dpp v53, v80, v5 row_newbcast:2 row_mask:0xf bank_mask:0xf
    v_and_b32_dpp v54, v80, v6 row_newbcast:2 row_mask:0xf bank_mask:0xf
    v_and_b32_dpp v55, v80, v7 row_newbcast:2 row_mask:0xf bank_mask:0xf
    v_mfma_f32_16x16x32_bf16 v[32:35], v[56:59], v[116:119], v[32:35]
    v_mfma_f32_16x16x32_bf16 v[36:39], v[56:59], v[120:123], v[36:39]
    v_mfma_f32_16x16x32_bf16 v[40:43], v[56:59], v[124:127], v[40:43]
    v_mfma_f32_16x16x32_bf16 v[44:47], v[56:59], v[128:131], v[44:47]
    v_mfma_f32_16x16x32_bf16 v[48:51], v[56:59], v[132:135], v[48:51]
    v_and_b32_dpp v56, v80, v4 row_newbcast:3 row_mask:0xf bank_mask:0xf
    v_and_b32_dpp v57, v80, v5 row_newbcast:3 row_mask:0xf bank_mask:0xf
    v_and_b32_dpp v58, v80, v6 row_newbcast:3 row_mask:0xf bank_mask:0xf
    v_and_b32_dpp v59, v80, v7 row_newbcast:3 row_mask:0xf bank_mask:0xf
    v_mfma_f32_16x16x32_bf16 v[32:35], v[52:55], v[136:139], v[32:35]
    v_mfma_f32_16x16x32_bf16 v[36:39], v[52:55], v[140:143], v[36:39]
    v_mfma_f32_16x16x32_bf16 v[40:43], v[52:55], v[144:147], v[40:43]
    v_mfma_f32_16x16x32_bf16 v[44:47], v[52:55], v[148:151], v[44:47]
    v_mfma_f32_16x16x32_bf16 v[48:51], v[52:55], v[152:155], v[48:51]
    v_and_b32_dpp v52, v80, v4 row_newbcast:4 row_mask:0xf bank_mask:0xf
    v_and_b32_dpp v53, v80, v5 row_newbcast:4 row_mask:0xf bank_mask:0xf
    v_and_b32_dpp v54, v80, v6 row_newbcast:4 row_mask:0xf bank_mask:0xf
    v_and_b32_dpp v55, v80, v7 row_newbcast:4 row_mask:0xf bank_mask:0xf
    v_mfma_f32_16x16x32_bf16 v[32:35], v[56:59], v[156:159], v[32:35]
    v_mfma_f32_16x16x32_bf16 v[36:39], v[56:59], v[160:163], v[36:39]
    v_mfma_f32_16x16x32_bf16 v[40:43], v[56:59], v[164:167], v[40:43]
    v_mfma_f32_16x16x32_bf16 v[44:47], v[56:59], v[168:171], v[44:47]
    v_mfma_f32_16x16x32_bf16 v[48:51], v[56:59], v[172:175], v[48:51]
    v_and_b32_dpp v56, v80, v4 row_newbcast:5 row_mask:0xf bank_mask:0xf
    v_and_b32_dpp v57, v80, v5 row_newbcast:5 row_mask:0xf bank_mask:0xf
    v_and_b32_dpp v58, v80, v6 row_newbcast:5 row_mask:0xf bank_mask:0xf
    v_and_b32_dpp v59, v80, v7 row_newbcast:5 row_mask:0xf bank_mask:0xf
    v_mfma_f32_16x16x32_bf16 v[32:35], v[52:55], v[176:179], v[32:35]
    v_mfma_f32_16x16x32_bf16 v[36:39], v[52:55], v[180:183], v[36:39]
    v_mfma_f32_16x16x32_bf16 v[40:43], v[52:55], v[184:187], v[40:43]
    v_mfma_f32_16x16x32_bf16 v[44:47], v[52:55], v[188:191], v[44:47]
    v_mfma_f32_16x16x32_bf16 v[48:51], v[52:55], v[192:195], v[48:51]
    v_and_b32_dpp v52, v80, v4 row_newbcast:6 row_mask:0xf bank_mask:0xf
    v_and_b32_dpp v53, v80, v5 row_newbcast:6 row_mask:0xf bank_mask:0xf
    v_and_b32_dpp v54, v80, v6 row_newbcast:6 row_mask:0xf bank_mask:0xf
    v_and_b32_dpp v55, v80, v7 row_newbcast:6 row_mask:0xf bank_mask:0xf
    v_mfma_f32_16x16x32_bf16 v[32:35], v[56:59], v[196:199], v[32:35]
    v_mfma_f32_16x16x32_bf16 v[36:39], v[56:59], v[200:203], v[36:39]
    v_mfma_f32_16x16x32_bf16 v[40:43], v[56:59], v[204:207], v[40:43]
    v_mfma_f32_16x16x32_bf16 v[44:47], v[56:59], v[208:211], v[44:47]
    v_mfma_f32_16x16x32_bf16 v[48:51], v[56:59], v[212:215], v[48:51]
    v_and_b32_dpp v56, v80, v4 row_newbcast:7 row_mask:0xf bank_mask:0xf
    v_and_b32_dpp v57, v80, v5 row_newbcast:7 row_mask:0xf bank_mask:0xf
    v_and_b32_dpp v58, v80, v6 row_newbcast:7 row_mask:0xf bank_mask:0xf
    v_and_b32_dpp v59, v80, v7 row_newbcast:7 row_mask:0xf bank_mask:0xf
    v_mfma_f32_16x16x32_bf16 v[32:35], v[52:55], v[216:219], v[32:35]
    v_mfma_f32_16x16x32_bf16 v[36:39], v[52:55], v[220:223], v[36:39]
    v_mfma_f32_16x16x32_bf16 v[40:43], v[52:55], v[224:227], v[40:43]
    v_mfma_f32_16x16x32_bf16 v[44:47], v[52:55], v[228:231], v[44:47]
    v_mfma_f32_16x16x32_bf16 v[48:51], v[52:55], v[232:235], v[48:51]
    s_nop 1
    v_mfma_f32_16x16x32_bf16 v[32:35], v[56:59], v[236:239], v[32:35]
    v_mfma_f32_16x16x32_bf16 v[36:39], v[56:59], v[240:243], v[36:39]
    v_mfma_f32_16x16x32_bf16 v[40:43], v[56:59], v[244:247], v[40:43]
    v_mfma_f32_16x16x32_bf16 v[44:47], v[56:59], v[248:251], v[44:47]
    v_mfma_f32_16x16x32_bf16 v[48:51], v[56:59], v[252:255], v[48:51]
    s_mov_b32 exec_hi, 0
    s_nop 4
    ds_write_b128 v8, v[32:35] offset:4608
    ds_write_b128 v8, v[36:39] offset:5120
    ds_write_b128 v8, v[40:43] offset:5632
    ds_write_b128 v8, v[44:47] offset:6144
    ds_write_b128 v8, v[48:51] offset:6656
    s_mov_b64 exec, -1
    s_waitcnt lgkmcnt(0)
    s_barrier
    s_mov_b32 exec_lo, -1
    s_mov_b32 exec_hi, 0xff
    ds_read_b128 v[64:67], v92 offset:4608
    ds_read_b128 v[68:71], v92 offset:7168
    ds_read_b128 v[72:75], v92 offset:9728
    ds_read_b128 v[76:79], v92 offset:12288
    v_mov_b32 v88, s72
    s_waitcnt lgkmcnt(0)
    v_add_f32 v64, v64, v68
    v_add_f32 v72, v72, v76
    v_add_f32 v65, v65, v69
    v_add_f32 v73, v73, v77
    v_add_f32 v66, v66, v70
    v_add_f32 v74, v74, v78
    v_add_f32 v67, v67, v71
    v_add_f32 v75, v75, v79
    v_add_f32 v64, v64, v72
    v_add_f32 v65, v65, v73
    v_add_f32 v66, v66, v74
    v_add_f32 v67, v67, v75
    v_add_u32 v80, 0x80, v64
    v_add_u32 v81, 0x80, v65
    v_add_u32 v82, 0x80, v66
    v_add_u32 v83, 0x80, v67
    v_perm_b32 v80, v80, v88, s92
    v_perm_b32 v81, v81, v88, s93
    v_perm_b32 v82, v82, v88, s94
    v_perm_b32 v83, v83, v88, s95
    buffer_store_dwordx4 v[80:83], v94, s[64:67], s77 offen sc1
    s_mov_b64 exec, -1
    s_cmp_lg_u32 s34, 0
    s_cbranch_scc1 L_flush
    s_cmp_ge_u32 s31, 20
    s_cbranch_scc1 L_flush
    s_lshl_b32 s35, s31, 13
    s_add_u32 s35, s35, s76
    v_lshlrev_b32 v9, 4, v0
    v_add_u32 v10, 0x1000, v9
    s_mov_b32 s36, 20000
L_poll2:
    buffer_load_dwordx4 v[96:99], v9, s[64:67], s35 offen offset:0 sc1
    buffer_load_dwordx4 v[100:103], v9, s[64:67], s35 offen offset:1024 sc1
    buffer_load_dwordx4 v[104:107], v9, s[64:67], s35 offen offset:2048 sc1
    buffer_load_dwordx4 v[108:111], v9, s[64:67], s35 offen offset:3072 sc1
    buffer_load_dwordx4 v[112:115], v10, s[64:67], s35 offen offset:0 sc1
    buffer_load_dwordx4 v[116:119], v10, s[64:67], s35 offen offset:1024 sc1
    buffer_load_dwordx4 v[120:123], v10, s[64:67], s35 offen offset:2048 sc1
    buffer_load_dwordx4 v[124:127], v10, s[64:67], s35 offen offset:3072 sc1
    s_waitcnt vmcnt(0)
    v_perm_b32 v64, v97, v96, s96
    v_perm_b32 v64, v98, v64, s97
    v_perm_b32 v64, v99, v64, s98
    v_perm_b32 v65, v101, v100, s96
    v_perm_b32 v65, v102, v65, s97
    v_perm_b32 v65, v103, v65, s98
    v_perm_b32 v66, v105, v104, s96
    v_perm_b32 v66, v106, v66, s97
    v_perm_b32 v66, v107, v66, s98
    v_perm_b32 v67, v109, v108, s96
    v_perm_b32 v67, v110, v67, s97
    v_perm_b32 v67, v111, v67, s98
    v_perm_b32 v68, v113, v112, s96
    v_perm_b32 v68, v114, v68, s97
    v_perm_b32 v68, v115, v68, s98
    v_perm_b32 v69, v117, v116, s96
    v_perm_b32 v69, v118, v69, s97
    v_perm_b32 v69, v119, v69, s98
    v_perm_b32 v70, v121, v120, s96
    v_perm_b32 v70, v122, v70, s97
    v_perm_b32 v70, v123, v70, s98
    v_perm_b32 v71, v125, v124, s96
    v_perm_b32 v71, v126, v71, s97
    v_perm_b32 v71, v127, v71, s98
    v_min3_u32 v80, v64, v65, v66
    v_max3_u32 v81, v64, v65, v66
    v_min3_u32 v80, v80, v67, v68
    v_max3_u32 v81, v81, v67, v68
    v_min3_u32 v80, v80, v69, v70
    v_max3_u32 v81, v81, v69, v70
    v_min_u32 v80, v80, v71
    v_max_u32 v81, v81, v71
    v_cmp_ne_u32 vcc, s72, v80
    v_cmp_ne_u32_e64 s[74:75], s72, v81
    s_nop 1
    s_or_b64 s[74:75], vcc, s[74:75]
    s_cbranch_scc0 L_poll2_done
    s_sub_u32 s36, s36, 1
    s_cmp_lg_u32 s36, 0
    s_cbranch_scc1 L_poll2
L_poll2_done:
    v_and_b32 v96, 0xffffff00, v96
    v_and_b32 v97, 0xffffff00, v97
    v_and_b32 v98, 0xffffff00, v98
    v_and_b32 v99, 0xffffff00, v99
    v_and_b32 v100, 0xffffff00, v100
    v_and_b32 v101, 0xffffff00, v101
    v_and_b32 v102, 0xffffff00, v102
    v_and_b32 v103, 0xffffff00, v103
    v_and_b32 v104, 0xffffff00, v104
    v_and_b32 v105, 0xffffff00, v105
    v_and_b32 v106, 0xffffff00, v106
    v_and_b32 v107, 0xffffff00, v107
    v_and_b32 v108, 0xffffff00, v108
    v_and_b32 v109, 0xffffff00, v109
    v_and_b32 v110, 0xffffff00, v110
    v_and_b32 v111, 0xffffff00, v111
    v_and_b32 v112, 0xffffff00, v112
    v_and_b32 v113, 0xffffff00, v113
    v_and_b32 v114, 0xffffff00, v114
    v_and_b32 v115, 0xffffff00, v115
    v_and_b32 v116, 0xffffff00, v116
    v_and_b32 v117, 0xffffff00, v117
    v_and_b32 v118, 0xffffff00, v118
    v_and_b32 v119, 0xffffff00, v119
    v_and_b32 v120, 0xffffff00, v120
    v_and_b32 v121, 0xffffff00, v121
    v_and_b32 v122, 0xffffff00, v122
    v_and_b32 v123, 0xffffff00, v123
    v_and_b32 v124, 0xffffff00, v124
    v_and_b32 v125, 0xffffff00, v125
    v_and_b32 v126, 0xffffff00, v126
    v_and_b32 v127, 0xffffff00, v127
    v_add_f32 v96, v96, v100
    v_add_f32 v104, v104, v108
    v_add_f32 v112, v112, v116
    v_add_f32 v120, v120, v124
    v_add_f32 v97, v97, v101
    v_add_f32 v105, v105, v109
    v_add_f32 v113, v113, v117
    v_add_f32 v121, v121, v125
    v_add_f32 v98, v98, v102
    v_add_f32 v106, v106, v110
    v_add_f32 v114, v114, v118
    v_add_f32 v122, v122, v126
    v_add_f32 v99, v99, v103
    v_add_f32 v107, v107, v111
    v_add_f32 v115, v115, v119
    v_add_f32 v123, v123, v127
    v_add_f32 v96, v96, v104
    v_add_f32 v112, v112, v120
    v_add_f32 v97, v97, v105
    v_add_f32 v113, v113, v121
    v_add_f32 v98, v98, v106
    v_add_f32 v114, v114, v122
    v_add_f32 v99, v99, v107
    v_add_f32 v115, v115, v123
    v_add_f32 v80, v96, v112
    v_add_f32 v81, v97, v113
    v_add_f32 v82, v98, v114
    v_add_f32 v83, v99, v115
    s_nop 1
    v_add_f32_dpp v80, v80, v80 row_ror:8 row_mask:0xf bank_mask:0xf
    v_add_f32_dpp v81, v81, v81 row_ror:8 row_mask:0xf bank_mask:0xf
    v_add_f32_dpp v82, v82, v82 row_ror:8 row_mask:0xf bank_mask:0xf
    v_add_f32_dpp v83, v83, v83 row_ror:8 row_mask:0xf bank_mask:0xf
    v_mov_b32 v84, v80
    v_mov_b32 v85, v81
    v_mov_b32 v86, v82
    v_mov_b32 v87, v83
    s_nop 1
    v_permlane16_swap_b32 v80, v84
    v_permlane16_swap_b32 v81, v85
    v_permlane16_swap_b32 v82, v86
    v_permlane16_swap_b32 v83, v87
    s_nop 0
    v_add_f32 v80, v80, v84
    v_add_f32 v81, v81, v85
    v_add_f32 v82, v82, v86
    v_add_f32 v83, v83, v87
    v_mov_b32 v84, v80
    v_mov_b32 v85, v81
    v_mov_b32 v86, v82
    v_mov_b32 v87, v83
    s_nop 1
    v_permlane32_swap_b32 v80, v84
    v_permlane32_swap_b32 v81, v85
    v_permlane32_swap_b32 v82, v86
    v_permlane32_swap_b32 v83, v87
    s_nop 0
    v_add_f32 v80, v80, v84
    v_add_f32 v81, v81, v85
    v_add_f32 v82, v82, v86
    v_add_f32 v83, v83, v87
    v_lshlrev_b32 v84, 16, v60
    v_and_b32 v85, 0xffff0000, v60
    v_lshlrev_b32 v86, 16, v61
    v_and_b32 v87, 0xffff0000, v61
    v_add_f32 v80, v80, v84
    v_add_f32 v81, v81, v85
    v_add_f32 v82, v82, v86
    v_add_f32 v83, v83, v87
    v_cvt_pk_bf16_f32 v80, v80, v81
    v_cvt_pk_bf16_f32 v81, v82, v83
    s_mul_i32 s35, s28, 1280
    s_lshl_b32 s36, s31, 6
    s_add_u32 s35, s35, s36
    v_lshlrev_b32 v9, 3, v0
    s_mov_b64 exec, 0xff
    buffer_store_dwordx2 v[80:81], v9, s[68:71], s35 offen
    s_or_b32 s36, s31, s28
    s_cmp_lg_u32 s36, 0
    s_cbranch_scc1 L_fin
    s_mov_b64 exec, 1
    v_mov_b32 v81, s72
    buffer_store_dword v81, off, s[64:67], 0 offset:0 sc1
L_fin:
L_flush:
L_end:
    s_endpgm
.section .rodata,"a"
.p2align 6
.amdhsa_kernel parallel_sum__gqa_block_cached__glu_gated_reglu__decode_kernel
  .amdhsa_next_free_vgpr 256
  .amdhsa_next_free_sgpr 102
  .amdhsa_accum_offset 256
  .amdhsa_group_segment_fixed_size 0
  .amdhsa_kernarg_size 96
  .amdhsa_user_sgpr_count 2
  .amdhsa_user_sgpr_kernarg_segment_ptr 1
  .amdhsa_system_sgpr_workgroup_id_x 1
.end_amdhsa_kernel
```
